```python
import torch

def _softmax(x, axis=-1):
    return torch.softmax(x, dim=axis)
def _gelu(x):
    return torch.nn.functional.gelu(x, approximate="tanh")
def _silu(x):
    return torch.nn.functional.silu(x)
def _sigmoid(x):
    return torch.sigmoid(x)
def _layernorm(x, axis=-1, eps=1e-5):
    m = x.mean(dim=axis, keepdim=True)
    v = x.var(dim=axis, keepdim=True, unbiased=False)
    return (x - m) / torch.sqrt(v + eps)
def _scatter_add(tgt, idx, src, axis=0):
    return tgt.clone().index_add_(axis, idx, src)
def _segment_sum(src, seg, n):
    out = torch.zeros((n,) + src.shape[1:], dtype=src.dtype)
    return out.index_add_(0, seg, src)
def _pad(x, pw):
    flat = tuple(v for pair in reversed(pw) for v in pair)
    return torch.nn.functional.pad(x, flat)

kernel_name = 'sequential_preLN__spectral_fnet__dense_activation_squared_relu__prompt'

def setup_inputs():

    _w = (lambda a: (lambda t: t.to(torch.bfloat16) if t.is_floating_point() else t)(torch.as_tensor(a)))
    def _A_setup():
        B, S, D = 1, 2048, 640
        ns = torch.arange(S)[:, None] * torch.arange(S)[None, :]
        nd = torch.arange(D)[:, None] * torch.arange(D)[None, :]
        Ws_re = torch.cos(-2.0 * torch.pi * ns / S).to(float)
        Ws_im = torch.sin(-2.0 * torch.pi * ns / S).to(float)
        Wd_re = torch.cos(-2.0 * torch.pi * nd / D).to(float)
        Wd_im = torch.sin(-2.0 * torch.pi * nd / D).to(float)
        return {
            "x": _w((lambda *s: torch.randn(*s, dtype=torch.bfloat16) * 0.05)(B, S, D)),
            "dft_seq_re": _w(Ws_re),
            "dft_seq_im": _w(Ws_im),
            "dft_hid_re": _w(Wd_re),
            "dft_hid_im": _w(Wd_im),
        }
    _A_in = _A_setup()

    def _B_setup():
        B, S, D, F = 1, 2048, 640, 1536
        return {
            "x": _w((lambda *s: torch.randn(*s, dtype=torch.bfloat16) * 0.05)(B, S, D)),
            "w1": _w((lambda *s: torch.randn(*s, dtype=torch.bfloat16) * 0.2)(D, F)),
            "b1": _w((lambda *s: torch.randn(*s, dtype=torch.bfloat16) * 0.2)(F)),
            "w2": _w((lambda *s: torch.randn(*s, dtype=torch.bfloat16) * 0.2)(F, D)),
            "b2": _w((lambda *s: torch.randn(*s, dtype=torch.bfloat16) * 0.2)(D)),
        }
    _B_in = _B_setup()

    return {
        "A_x": _A_in["x"],
        "A_dft_seq_re": _A_in["dft_seq_re"],
        "A_dft_seq_im": _A_in["dft_seq_im"],
        "A_dft_hid_re": _A_in["dft_hid_re"],
        "A_dft_hid_im": _A_in["dft_hid_im"],
        "B_x": _B_in["x"],
        "B_w1": _B_in["w1"],
        "B_b1": _B_in["b1"],
        "B_w2": _B_in["w2"],
        "B_b2": _B_in["b2"],
    }

def reference(A_x, A_dft_seq_re, A_dft_seq_im, A_dft_hid_re, A_dft_hid_im, B_x, B_w1, B_b1, B_w2, B_b2):
    def _A_ref(x, dft_seq_re, dft_seq_im, dft_hid_re, dft_hid_im):
        a = torch.einsum("bsd,ed->bse", x, dft_hid_re)
        b = torch.einsum("bsd,ed->bse", x, dft_hid_im)
        y = torch.einsum("ts,bse->bte", dft_seq_re, a) - torch.einsum("ts,bse->bte", dft_seq_im, b)
        return y

    def _B_ref(x, w1, b1, w2, b2):
        h = torch.einsum("bsd,df->bsf", x, w1) + b1
        zero = torch.zeros_like(h)
        r = torch.where(h > zero, h, zero)
        h = r * r
        out = torch.einsum("bsf,fd->bsd", h, w2) + b2
        return out

    x = A_x
    h = x + _A_ref(_layernorm(x, axis=-1), A_dft_seq_re, A_dft_seq_im, A_dft_hid_re, A_dft_hid_im)
    h2 = h + _B_ref(_layernorm(h, axis=-1), B_w1, B_b1, B_w2, B_b2)
    return h2
```

```asm
; @launch kernel=fnet_a_kernel grid=(256,1,1) block=(1024,1,1) lds=114816
; @launch kernel=fnet_cd_kernel grid=(256,1,1) block=(256,1,1) lds=147456
.amdgcn_target "amdgcn-amd-amdhsa--gfx950"
.text
.globl fnet_a_kernel
.p2align 8
.type fnet_a_kernel,@function
fnet_a_kernel:
    s_cmp_ge_u32 s2, 256
    s_cbranch_scc1 fnet_a_kernel_end
    s_load_dwordx2 s[8:9], s[0:1], 0
    s_load_dwordx2 s[12:13], s[0:1], 96
    s_load_dwordx2 s[16:17], s[0:1], 48
    s_load_dwordx2 s[18:19], s[0:1], 64
    v_lshrrev_b32 v1, 6, v0
    v_and_b32 v2, 63, v0
    v_readfirstlane_b32 s22, v1
    v_and_b32 v7, 15, v2
    v_lshrrev_b32 v8, 4, v2
    s_and_b32 s24, s2, 7
    s_lshr_b32 s25, s2, 3
    s_cmp_lt_u32 s25, 20
    s_cbranch_scc1 fnet_a_kernel_fft_norm
    s_cmp_ge_u32 s25, 25
    s_cbranch_scc1 fnet_a_kernel_pack_hi
    s_cmp_eq_u32 s24, 0
    s_cbranch_scc0 fnet_a_kernel_pack_lo
    s_mov_b32 s20, 32
    s_sub_u32 s21, s25, 20
    s_mov_b32 s23, 2
    s_branch fnet_a_kernel_fft
fnet_a_kernel_fft_norm:
    s_mul_i32 s26, s25, 52
    s_lshr_b32 s26, s26, 8
    s_mul_i32 s27, s26, 5
    s_sub_u32 s21, s25, s27
    s_lshl_b32 s27, s24, 2
    s_add_u32 s27, s27, s26
    s_lshr_b32 s20, s27, 1
    s_sub_u32 s28, 32, s20
    s_cmp_eq_u32 s27, 1
    s_cselect_b32 s28, 16, s28
    s_bitcmp1_b32 s27, 0
    s_cselect_b32 s20, s28, s20
    s_lshl_b32 s23, s26, 2
fnet_a_kernel_fft:
    v_lshl_add_u32 v3, v1, 2, v8
    v_and_b32 v5, 31, v3
    v_lshlrev_b32 v5, 6, v5
    v_add_u32 v5, s20, v5
    v_sub_u32 v6, 0x800, v5
    v_and_b32 v6, 0x7ff, v6
    v_cmp_gt_u32 vcc, 32, v3
    v_lshlrev_b32 v4, 4, v7
    s_nop 0
    v_cndmask_b32 v5, v6, v5, vcc
    v_mul_u32_u24 v5, 1280, v5
    v_add_u32 v5, v5, v4
    v_mul_u32_u24 v6, 1280, v3
    v_add_u32 v6, v6, v4
    s_waitcnt lgkmcnt(0)
    s_mov_b32 s10, 2621440
    s_mov_b32 s11, 0x20000
    buffer_load_dwordx4 v[64:67], v5, s[8:11], 0 offen offset:0
    buffer_load_dwordx4 v[68:71], v5, s[8:11], 0 offen offset:256
    buffer_load_dwordx4 v[72:75], v5, s[8:11], 0 offen offset:512
    buffer_load_dwordx4 v[76:79], v5, s[8:11], 0 offen offset:768
    buffer_load_dwordx4 v[80:83], v5, s[8:11], 0 offen offset:1024
    s_mov_b32 s14, 14323712
    s_mov_b32 s15, 0x20000
    v_lshlrev_b32 v9, 2, v8
    v_cvt_f32_u32 v9, v9
    s_lshl_b32 s26, s21, 3
    s_add_u32 s26, s26, 1
    v_and_b32 v10, 7, v7
    v_add_u32 v10, s26, v10
    v_cvt_f32_u32 v10, v10
    v_mul_f32 v10, 0x3ccccccd, v10
    v_lshrrev_b32 v11, 3, v7
    v_cvt_f32_u32 v11, v11
    v_mul_f32 v11, 0x3e800000, v11
    v_fma_f32 v11, v10, v9, v11
    v_fmamk_f32 v44, v10, 0x00000000, v11
    v_fmamk_f32 v45, v10, 0x3f800000, v11
    v_fmamk_f32 v46, v10, 0x40000000, v11
    v_fmamk_f32 v47, v10, 0x40400000, v11
    v_fmamk_f32 v48, v10, 0x41800000, v11
    v_fmamk_f32 v49, v10, 0x41880000, v11
    v_fmamk_f32 v50, v10, 0x41900000, v11
    v_fmamk_f32 v51, v10, 0x41980000, v11
    v_fmamk_f32 v52, v10, 0x42000000, v11
    v_fmamk_f32 v53, v10, 0x42040000, v11
    v_fmamk_f32 v54, v10, 0x42080000, v11
    v_fmamk_f32 v55, v10, 0x420c0000, v11
    v_cos_f32 v44, v44
    v_cos_f32 v45, v45
    v_cos_f32 v46, v46
    v_cos_f32 v47, v47
    v_cos_f32 v48, v48
    v_cos_f32 v49, v49
    v_cos_f32 v50, v50
    v_cos_f32 v51, v51
    v_cos_f32 v52, v52
    v_cos_f32 v53, v53
    v_cos_f32 v54, v54
    v_cos_f32 v55, v55
    v_cvt_pk_bf16_f32 v20, v44, v45
    v_cvt_pk_bf16_f32 v21, v46, v47
    v_cvt_pk_bf16_f32 v22, v48, v49
    v_cvt_pk_bf16_f32 v23, v50, v51
    v_cvt_pk_bf16_f32 v24, v52, v53
    v_cvt_pk_bf16_f32 v25, v54, v55
    v_cmp_gt_u32 vcc, 2, v8
    v_mov_b32 v60, 0x3f803f80
    v_mov_b32 v61, 0x3f803f80
    v_mov_b32 v62, 0x3f803f80
    v_mov_b32 v63, 0x3f803f80
    v_cndmask_b32 v24, 0, v24, vcc
    v_cndmask_b32 v25, 0, v25, vcc
    v_mfma_f32_16x16x32_bf16 v[84:87], v[60:63], v[20:23], 0
    s_nop 0
    v_mfma_f32_16x16x16_bf16 v[88:91], v[60:61], v[24:25], 0
    s_and_b32 s27, s22, 7
    s_add_u32 s28, s27, s26
    v_lshrrev_b32 v10, 1, v7
    v_mul_u32_u24 v10, 40, v10
    v_add_u32 v10, s28, v10
    v_and_b32 v11, 1, v7
    v_cvt_f32_u32 v12, v11
    v_mul_f32 v12, 0x3e800000, v12
    v_mov_b32 v13, 0x80008000
    v_mul_lo_u32 v13, v13, v11
    v_cvt_f32_u32 v14, v10
    v_mul_f32 v14, 0x3acccccd, v14
    v_fma_f32 v44, v14, v9, v12
    v_fmamk_f32 v45, v14, 0x3f800000, v44
    v_fmamk_f32 v46, v14, 0x40000000, v44
    v_fmamk_f32 v47, v14, 0x40400000, v44
    v_add_f32 v26, v84, v88
    v_sin_f32 v48, v44
    v_sin_f32 v49, v45
    v_sin_f32 v50, v46
    v_sin_f32 v51, v47
    v_cos_f32 v44, v44
    v_cos_f32 v45, v45
    v_cos_f32 v46, v46
    v_cos_f32 v47, v47
    v_cvt_pk_f16_f32 v28, v44, v45
    v_cvt_pk_f16_f32 v29, v46, v47
    v_cvt_pk_f16_f32 v30, v48, v49
    v_cvt_pk_f16_f32 v31, v50, v51
    v_xor_b32 v32, v13, v28
    v_xor_b32 v33, v13, v29
    v_xor_b32 v34, v13, v30
    v_xor_b32 v35, v13, v31
    s_lshr_b32 s29, s22, 3
    s_lshl_b32 s30, s29, 4
    v_add_u32 v15, s30, v7
    v_cvt_f32_u32 v10, v15
    v_mul_f32 v10, 0x3d000000, v10
    s_cmp_eq_u32 s20, 32
    s_cselect_b32 s31, 0x3f000000, 0
    v_add_f32 v11, s31, v9
    v_mul_f32 v11, v10, v11
    v_fmamk_f32 v44, v10, 0x00000000, v11
    v_fmamk_f32 v45, v10, 0x3f800000, v11
    v_fmamk_f32 v46, v10, 0x40000000, v11
    v_fmamk_f32 v47, v10, 0x40400000, v11
    v_fmamk_f32 v48, v10, 0x41800000, v11
    v_fmamk_f32 v49, v10, 0x41880000, v11
    v_fmamk_f32 v50, v10, 0x41900000, v11
    v_fmamk_f32 v51, v10, 0x41980000, v11
    v_sin_f32 v52, v44
    v_sin_f32 v53, v45
    v_sin_f32 v54, v46
    v_sin_f32 v55, v47
    v_sin_f32 v56, v48
    v_sin_f32 v57, v49
    v_sin_f32 v58, v50
    v_sin_f32 v59, v51
    v_cos_f32 v44, v44
    v_cos_f32 v45, v45
    v_cos_f32 v46, v46
    v_cos_f32 v47, v47
    v_cos_f32 v48, v48
    v_cos_f32 v49, v49
    v_cos_f32 v50, v50
    v_cos_f32 v51, v51
    v_cvt_pk_f16_f32 v36, v44, v45
    v_cvt_pk_f16_f32 v40, v52, v53
    v_cvt_pk_f16_f32 v37, v46, v47
    v_cvt_pk_f16_f32 v41, v54, v55
    v_cvt_pk_f16_f32 v38, v48, v49
    v_cvt_pk_f16_f32 v42, v56, v57
    v_cvt_pk_f16_f32 v39, v50, v51
    v_cvt_pk_f16_f32 v43, v58, v59
    s_mul_i32 s32, s22, 5120
    v_lshlrev_b32 v10, 3, v2
    v_add_u32 v10, s32, v10
    v_and_b32 v11, 31, v2
    v_lshlrev_b32 v11, 3, v11
    v_add_u32 v11, s32, v11
    v_and_b32 v12, 7, v7
    v_mul_u32_u24 v12, 4112, v12
    v_lshl_add_u32 v12, v8, 8, v12
    v_lshrrev_b32 v13, 3, v7
    v_lshl_add_u32 v12, v13, 3, v12
    s_lshr_b32 s33, s22, 2
    s_lshl_b32 s33, s33, 10
    s_and_b32 s34, s22, 3
    s_lshl_b32 s34, s34, 6
    s_add_u32 s33, s33, s34
    s_add_u32 s33, s33, 81920
    v_add_u32 v12, s33, v12
    s_mul_i32 s34, s27, 4112
    s_add_u32 s34, s34, 81920
    v_lshlrev_b32 v13, 4, v2
    v_add_u32 v13, s34, v13
    v_mul_u32_u24 v14, 260, v15
    v_lshl_add_u32 v14, v8, 6, v14
    s_lshl_b32 s34, s27, 2
    v_add_u32 v14, s34, v14
    s_mul_i32 s34, s22, 520
    v_lshlrev_b32 v15, 2, v2
    v_add_u32 v15, s34, v15
    v_lshrrev_b32 v16, 3, v2
    v_mul_u32_u24 v16, 40, v16
    v_and_b32 v17, 7, v2
    v_add_lshl_u32 v16, v16, v17, 4
    s_mul_i32 s36, s22, 81920
    s_mul_i32 s37, s24, 5120
    s_add_u32 s36, s36, s37
    s_lshl_b32 s37, s21, 7
    s_add_u32 s36, s36, s37
    s_add_u32 s36, s36, s23
    s_add_u32 s36, s36, 256
    s_add_u32 s37, s36, 40960
    s_and_b32 s35, s20, 31
    v_mov_b32 v56, 0
    v_mov_b32 v57, 0
    v_mov_b32 v58, 0
    v_mov_b32 v59, 0
    s_waitcnt vmcnt(4)
    ds_write_b128 v6, v[64:67] offset:0
    v_dot2c_f32_bf16 v56, v64, v60
    v_dot2c_f32_bf16 v58, v64, v64
    v_dot2c_f32_bf16 v57, v65, v60
    v_dot2c_f32_bf16 v59, v65, v65
    v_dot2c_f32_bf16 v56, v66, v60
    v_dot2c_f32_bf16 v58, v66, v66
    v_dot2c_f32_bf16 v57, v67, v60
    v_dot2c_f32_bf16 v59, v67, v67
    s_waitcnt vmcnt(3)
    ds_write_b128 v6, v[68:71] offset:256
    v_dot2c_f32_bf16 v56, v68, v60
    v_dot2c_f32_bf16 v58, v68, v68
    v_dot2c_f32_bf16 v57, v69, v60
    v_dot2c_f32_bf16 v59, v69, v69
    v_dot2c_f32_bf16 v56, v70, v60
    v_dot2c_f32_bf16 v58, v70, v70
    v_dot2c_f32_bf16 v57, v71, v60
    v_dot2c_f32_bf16 v59, v71, v71
    s_waitcnt vmcnt(2)
    ds_write_b128 v6, v[72:75] offset:512
    v_dot2c_f32_bf16 v56, v72, v60
    v_dot2c_f32_bf16 v58, v72, v72
    v_dot2c_f32_bf16 v57, v73, v60
    v_dot2c_f32_bf16 v59, v73, v73
    v_dot2c_f32_bf16 v56, v74, v60
    v_dot2c_f32_bf16 v58, v74, v74
    v_dot2c_f32_bf16 v57, v75, v60
    v_dot2c_f32_bf16 v59, v75, v75
    s_waitcnt vmcnt(1)
    ds_write_b128 v6, v[76:79] offset:768
    v_dot2c_f32_bf16 v56, v76, v60
    v_dot2c_f32_bf16 v58, v76, v76
    v_dot2c_f32_bf16 v57, v77, v60
    v_dot2c_f32_bf16 v59, v77, v77
    v_dot2c_f32_bf16 v56, v78, v60
    v_dot2c_f32_bf16 v58, v78, v78
    v_dot2c_f32_bf16 v57, v79, v60
    v_dot2c_f32_bf16 v59, v79, v79
    s_waitcnt vmcnt(0)
    ds_write_b128 v6, v[80:83] offset:1024
    ds_read_b64_tr_b16 v[96:97], v10 offset:0
    ds_read_b64_tr_b16 v[98:99], v10 offset:512
    ds_read_b64_tr_b16 v[100:101], v11 offset:1024
    ds_read_b64_tr_b16 v[102:103], v10 offset:1280
    ds_read_b64_tr_b16 v[104:105], v10 offset:1792
    ds_read_b64_tr_b16 v[106:107], v11 offset:2304
    ds_read_b64_tr_b16 v[108:109], v10 offset:2560
    ds_read_b64_tr_b16 v[110:111], v10 offset:3072
    ds_read_b64_tr_b16 v[112:113], v11 offset:3584
    ds_read_b64_tr_b16 v[114:115], v10 offset:3840
    ds_read_b64_tr_b16 v[116:117], v10 offset:4352
    ds_read_b64_tr_b16 v[118:119], v11 offset:4864
    v_dot2c_f32_bf16 v56, v80, v60
    v_dot2c_f32_bf16 v58, v80, v80
    v_dot2c_f32_bf16 v57, v81, v60
    v_dot2c_f32_bf16 v59, v81, v81
    v_dot2c_f32_bf16 v56, v82, v60
    v_dot2c_f32_bf16 v58, v82, v82
    v_dot2c_f32_bf16 v57, v83, v60
    v_dot2c_f32_bf16 v59, v83, v83
    s_nop 1
    v_add_f32 v56, v56, v57
    v_add_f32 v58, v58, v59
    s_waitcnt lgkmcnt(9)
    v_mfma_f32_16x16x32_bf16 v[84:87], v[96:99], v[20:23], 0
    v_add_f32_dpp v56, v56, v56 row_ror:8 row_mask:0xf bank_mask:0xf
    v_add_f32_dpp v58, v58, v58 row_ror:8 row_mask:0xf bank_mask:0xf
    s_waitcnt lgkmcnt(6)
    v_mfma_f32_16x16x32_bf16 v[88:91], v[102:105], v[20:23], 0
    v_add_f32_dpp v56, v56, v56 row_ror:4 row_mask:0xf bank_mask:0xf
    v_add_f32_dpp v58, v58, v58 row_ror:4 row_mask:0xf bank_mask:0xf
    s_waitcnt lgkmcnt(3)
    v_mfma_f32_16x16x32_bf16 v[92:95], v[108:111], v[20:23], 0
    v_add_f32_dpp v56, v56, v56 row_ror:2 row_mask:0xf bank_mask:0xf
    v_add_f32_dpp v58, v58, v58 row_ror:2 row_mask:0xf bank_mask:0xf
    s_waitcnt lgkmcnt(0)
    v_mfma_f32_16x16x32_bf16 v[44:47], v[114:117], v[20:23], 0
    v_add_f32_dpp v56, v56, v56 row_ror:1 row_mask:0xf bank_mask:0xf
    v_add_f32_dpp v58, v58, v58 row_ror:1 row_mask:0xf bank_mask:0xf
    v_mfma_f32_16x16x16_bf16 v[84:87], v[100:101], v[24:25], v[84:87]
    v_mul_f32 v56, 0x3acccccd, v56
    v_mul_f32 v58, 0x3acccccd, v58
    v_mfma_f32_16x16x16_bf16 v[88:91], v[106:107], v[24:25], v[88:91]
    v_fma_f32 v58, -v56, v56, v58
    v_max_f32 v58, 0, v58
    v_mfma_f32_16x16x16_bf16 v[92:95], v[112:113], v[24:25], v[92:95]
    v_add_f32 v58, 0x3727c5ac, v58
    v_rsq_f32 v58, v58
    v_mfma_f32_16x16x16_bf16 v[44:47], v[118:119], v[24:25], v[44:47]
    s_nop 0
    v_mul_f32 v56, v56, v58
    v_readlane_b32 s44, v58, 0
    v_readlane_b32 s45, v56, 0
    v_readlane_b32 s46, v58, 16
    v_readlane_b32 s47, v56, 16
    v_readlane_b32 s48, v58, 32
    v_readlane_b32 s49, v56, 32
    v_readlane_b32 s50, v58, 48
    v_readlane_b32 s51, v56, 48
    v_mul_f32 v48, s45, v26
    v_mul_f32 v50, s47, v26
    v_mul_f32 v52, s49, v26
    v_mul_f32 v54, s51, v26
    v_pk_fma_f32 v[84:85], v[84:85], s[44:45], v[48:49] op_sel_hi:[1,0,0] neg_lo:[0,0,1] neg_hi:[0,0,1]
    v_pk_fma_f32 v[86:87], v[86:87], s[44:45], v[48:49] op_sel_hi:[1,0,0] neg_lo:[0,0,1] neg_hi:[0,0,1]
    v_pk_fma_f32 v[88:89], v[88:89], s[46:47], v[50:51] op_sel_hi:[1,0,0] neg_lo:[0,0,1] neg_hi:[0,0,1]
    v_pk_fma_f32 v[90:91], v[90:91], s[46:47], v[50:51] op_sel_hi:[1,0,0] neg_lo:[0,0,1] neg_hi:[0,0,1]
    v_pk_fma_f32 v[92:93], v[92:93], s[48:49], v[52:53] op_sel_hi:[1,0,0] neg_lo:[0,0,1] neg_hi:[0,0,1]
    v_pk_fma_f32 v[94:95], v[94:95], s[48:49], v[52:53] op_sel_hi:[1,0,0] neg_lo:[0,0,1] neg_hi:[0,0,1]
    v_pk_fma_f32 v[44:45], v[44:45], s[50:51], v[54:55] op_sel_hi:[1,0,0] neg_lo:[0,0,1] neg_hi:[0,0,1]
    v_pk_fma_f32 v[46:47], v[46:47], s[50:51], v[54:55] op_sel_hi:[1,0,0] neg_lo:[0,0,1] neg_hi:[0,0,1]
    v_cvt_pk_f16_f32 v84, v84, v85
    v_cvt_pk_f16_f32 v85, v86, v87
    ds_write_b64 v12, v[84:85] offset:0
    v_cvt_pk_f16_f32 v88, v88, v89
    v_cvt_pk_f16_f32 v89, v90, v91
    ds_write_b64 v12, v[88:89] offset:16
    v_cvt_pk_f16_f32 v92, v92, v93
    v_cvt_pk_f16_f32 v93, v94, v95
    ds_write_b64 v12, v[92:93] offset:32
    v_cvt_pk_f16_f32 v44, v44, v45
    v_cvt_pk_f16_f32 v45, v46, v47
    ds_write_b64 v12, v[44:45] offset:48
    s_waitcnt lgkmcnt(0)
    s_barrier
    ds_read_b128 v[64:67], v13 offset:0
    ds_read_b128 v[72:75], v13 offset:2048
    ds_read_b128 v[68:71], v13 offset:1024
    ds_read_b128 v[76:79], v13 offset:3072
    s_waitcnt lgkmcnt(3)
    v_mfma_f32_16x16x32_f16 v[96:99], v[64:67], v[28:31], 0
    s_waitcnt lgkmcnt(2)
    v_mfma_f32_16x16x32_f16 v[96:99], v[72:75], v[32:35], v[96:99]
    s_waitcnt lgkmcnt(1)
    v_mfma_f32_16x16x32_f16 v[100:103], v[68:71], v[28:31], 0
    s_waitcnt lgkmcnt(0)
    v_mfma_f32_16x16x32_f16 v[100:103], v[76:79], v[32:35], v[100:103]
    s_nop 3
    v_cvt_pk_f16_f32 v104, v96, v97
    v_cvt_pk_f16_f32 v105, v98, v99
    s_nop 1
    v_cvt_pk_f16_f32 v106, v100, v101
    v_cvt_pk_f16_f32 v107, v102, v103
    s_nop 1
    v_mfma_f32_16x16x32_f16 v[108:111], v[104:107], v[36:39], 0
    v_mfma_f32_16x16x32_f16 v[112:115], v[104:107], v[40:43], 0
    s_nop 7
    v_add_f32 v108, v108, v113
    v_sub_f32 v109, v109, v112
    v_add_f32 v110, v110, v115
    v_sub_f32 v111, v111, v114
    v_cvt_pk_f16_f32 v116, v108, v109
    v_cvt_pk_f16_f32 v117, v110, v111
    ds_write2_b32 v14, v116, v117 offset0:0 offset1:8
    s_waitcnt lgkmcnt(0)
    s_barrier
    ds_read_b32 v118, v15
    ds_read_b32 v119, v15 offset:260
    s_cmp_eq_u32 s35, 0
    s_cbranch_scc1 fnet_a_kernel_short
    s_waitcnt lgkmcnt(0)
    buffer_store_dword v118, v16, s[12:15], s36 offen
    buffer_store_dword v119, v16, s[12:15], s37 offen
    s_branch fnet_a_kernel_fin
fnet_a_kernel_short:
    s_waitcnt lgkmcnt(0)
    buffer_store_short v118, v16, s[12:15], s36 offen
    buffer_store_short v119, v16, s[12:15], s37 offen
    s_branch fnet_a_kernel_fin
fnet_a_kernel_pack_lo:
    s_sub_u32 s26, s25, 20
    s_mul_i32 s26, s26, 7
    s_add_u32 s26, s26, s24
    s_sub_u32 s26, s26, 1
    s_branch fnet_a_kernel_pack
fnet_a_kernel_pack_hi:
    s_sub_u32 s26, s2, 165
fnet_a_kernel_pack:
    s_cmp_eq_u32 s26, 90
    s_cbranch_scc1 fnet_a_kernel_zero
    s_cmp_ge_u32 s26, 80
    s_cbranch_scc1 fnet_a_kernel_end
    v_lshrrev_b32 v9, 2, v7
    v_and_b32 v4, 3, v2
    v_lshlrev_b32 v3, 4, v2
    v_lshl_add_u32 v9, v8, 2, v9
    s_waitcnt lgkmcnt(0)
    s_mov_b32 s14, 14323712
    s_mov_b32 s15, 0x20000
    s_cmp_ge_u32 s26, 48
    s_cbranch_scc1 fnet_a_kernel_pack_w2
    s_cmp_ge_u32 s22, 10
    s_cbranch_scc1 fnet_a_kernel_end
    s_mov_b32 s8, s16
    s_mov_b32 s9, s17
    s_mov_b32 s10, 1966080
    s_mov_b32 s11, 0x20000
    v_lshrrev_b32 v5, 3, v2
    v_mul_u32_u24 v5, 3072, v5
    v_and_b32 v6, 7, v2
    v_lshl_add_u32 v5, v6, 4, v5
    s_lshr_b32 s27, s26, 1
    s_and_b32 s28, s26, 1
    s_mul_i32 s29, s28, 10
    s_add_u32 s29, s29, s22
    s_mul_i32 s30, s29, 98304
    s_lshl_b32 s31, s27, 7
    s_add_u32 s30, s30, s31
    s_lshl_b32 s31, s22, 12
    s_mov_b32 m0, s31
    s_nop 0
    buffer_load_dwordx4 v5, s[8:11], s30 offen lds
    s_add_u32 s30, s30, 24576
    s_add_u32 m0, m0, 1024
    s_nop 0
    buffer_load_dwordx4 v5, s[8:11], s30 offen lds
    s_add_u32 s30, s30, 24576
    s_add_u32 m0, m0, 1024
    s_nop 0
    buffer_load_dwordx4 v5, s[8:11], s30 offen lds
    s_add_u32 s30, s30, 24576
    s_add_u32 m0, m0, 1024
    s_nop 0
    buffer_load_dwordx4 v5, s[8:11], s30 offen lds
    v_lshlrev_b32 v6, 7, v9
    v_lshl_add_u32 v6, v4, 3, v6
    v_add_u32 v6, s31, v6
    v_mov_b32 v12, 0x3f803f80
    v_mov_b32 v13, 0x3f803f80
    v_mov_b32 v14, 0x3f803f80
    v_mov_b32 v15, 0x3f803f80
    s_mul_i32 s33, s27, 43
    s_lshr_b32 s33, s33, 7
    s_mul_i32 s34, s33, 3
    s_sub_u32 s34, s27, s34
    s_mul_i32 s33, s33, 240
    s_mul_i32 s35, s34, 120
    s_lshl_b32 s37, s29, 1
    s_add_u32 s35, s35, s37
    s_add_u32 s36, s35, 0
    s_add_u32 s37, s29, 40
    s_cmp_eq_u32 s34, 2
    s_cselect_b32 s36, s37, s36
    s_add_u32 s36, s36, s33
    s_lshl_b32 s36, s36, 10
    s_add_u32 s40, s36, 1314816
    s_add_u32 s36, s35, 1
    s_add_u32 s37, s29, 100
    s_cmp_eq_u32 s34, 2
    s_cselect_b32 s36, s37, s36
    s_add_u32 s36, s36, s33
    s_lshl_b32 s36, s36, 10
    s_add_u32 s41, s36, 1314816
    s_add_u32 s36, s35, 60
    s_add_u32 s37, s29, 160
    s_cmp_eq_u32 s34, 2
    s_cselect_b32 s36, s37, s36
    s_add_u32 s36, s36, s33
    s_lshl_b32 s36, s36, 10
    s_add_u32 s42, s36, 1314816
    s_add_u32 s36, s35, 61
    s_add_u32 s37, s29, 220
    s_cmp_eq_u32 s34, 2
    s_cselect_b32 s36, s37, s36
    s_add_u32 s36, s36, s33
    s_lshl_b32 s36, s36, 10
    s_add_u32 s43, s36, 1314816
    s_waitcnt vmcnt(0)
    ds_read_b64_tr_b16 v[20:21], v6 offset:0
    ds_read_b64_tr_b16 v[22:23], v6 offset:2048
    ds_read_b64_tr_b16 v[24:25], v6 offset:32
    ds_read_b64_tr_b16 v[26:27], v6 offset:2080
    ds_read_b64_tr_b16 v[28:29], v6 offset:64
    ds_read_b64_tr_b16 v[30:31], v6 offset:2112
    ds_read_b64_tr_b16 v[32:33], v6 offset:96
    ds_read_b64_tr_b16 v[34:35], v6 offset:2144
    s_waitcnt lgkmcnt(6)
    buffer_store_dwordx4 v[20:23], v3, s[12:15], s40 offen sc1
    v_mfma_f32_16x16x32_bf16 v[40:43], v[20:23], v[12:15], 0
    s_waitcnt lgkmcnt(4)
    buffer_store_dwordx4 v[24:27], v3, s[12:15], s41 offen sc1
    v_mfma_f32_16x16x32_bf16 v[44:47], v[24:27], v[12:15], 0
    s_waitcnt lgkmcnt(2)
    buffer_store_dwordx4 v[28:31], v3, s[12:15], s42 offen sc1
    v_mfma_f32_16x16x32_bf16 v[48:51], v[28:31], v[12:15], 0
    s_waitcnt lgkmcnt(0)
    buffer_store_dwordx4 v[32:35], v3, s[12:15], s43 offen sc1
    v_mfma_f32_16x16x32_bf16 v[52:55], v[32:35], v[12:15], 0
    v_lshlrev_b32 v10, 4, v8
    s_lshl_b32 s32, s22, 8
    s_add_u32 s32, s32, 40960
    v_add_u32 v10, s32, v10
    ds_write_b128 v10, v[40:43] offset:0
    ds_write_b128 v10, v[44:47] offset:64
    ds_write_b128 v10, v[48:51] offset:128
    s_nop 0
    ds_write_b128 v10, v[52:55] offset:192
    s_waitcnt lgkmcnt(0)
    s_barrier
    s_cmp_lg_u32 s22, 0
    s_cbranch_scc1 fnet_a_kernel_fin
    v_lshlrev_b32 v10, 2, v2
    ds_read_b32 v20, v10 offset:40960
    ds_read_b32 v21, v10 offset:41216
    ds_read_b32 v22, v10 offset:41472
    ds_read_b32 v23, v10 offset:41728
    ds_read_b32 v24, v10 offset:41984
    ds_read_b32 v25, v10 offset:42240
    ds_read_b32 v26, v10 offset:42496
    ds_read_b32 v27, v10 offset:42752
    ds_read_b32 v28, v10 offset:43008
    ds_read_b32 v29, v10 offset:43264
    s_mul_i32 s32, s28, 6144
    s_lshl_b32 s33, s27, 8
    s_add_u32 s32, s32, s33
    s_add_u32 s32, s32, 5246976
    s_waitcnt lgkmcnt(0)
    v_add_f32 v20, v20, v21
    v_add_f32 v20, v20, v22
    v_add_f32 v20, v20, v23
    v_add_f32 v20, v20, v24
    v_add_f32 v20, v20, v25
    v_add_f32 v20, v20, v26
    v_add_f32 v20, v20, v27
    v_add_f32 v20, v20, v28
    v_add_f32 v20, v20, v29
    buffer_store_dword v20, v10, s[12:15], s32 offen sc1
    s_branch fnet_a_kernel_fin
fnet_a_kernel_pack_w2:
    s_cmp_ge_u32 s22, 12
    s_cbranch_scc1 fnet_a_kernel_end
    s_mov_b32 s8, s18
    s_mov_b32 s9, s19
    s_mov_b32 s10, 1966080
    s_mov_b32 s11, 0x20000
    s_sub_u32 s27, s26, 48
    s_mul_i32 s27, s27, 12
    s_add_u32 s32, s27, s22
    s_cmp_ge_u32 s32, 384
    s_cbranch_scc1 fnet_a_kernel_end
    s_lshr_b32 s33, s32, 3
    s_and_b32 s34, s32, 7
    s_mul_i32 s35, s33, 40960
    s_mul_i32 s36, s34, 160
    s_add_u32 s35, s35, s36
    s_mul_i32 s36, s34, 48
    s_add_u32 s36, s36, s33
    s_mul_i32 s36, s36, 5120
    s_add_u32 s40, s36, 3280896
    s_mul_i32 s29, s22, 5120
    s_mov_b32 m0, s29
    v_add_u32 v10, 0, v2
    v_mul_u32_u24 v11, 205, v10
    v_lshrrev_b32 v11, 11, v11
    v_mul_u32_u24 v12, 10, v11
    v_sub_u32 v12, v10, v12
    v_mul_u32_u24 v11, 1280, v11
    v_lshl_add_u32 v14, v12, 4, v11
    buffer_load_dwordx4 v14, s[8:11], s35 offen lds
    s_add_u32 m0, m0, 1024
    v_add_u32 v10, 64, v2
    v_mul_u32_u24 v11, 205, v10
    v_lshrrev_b32 v11, 11, v11
    v_mul_u32_u24 v12, 10, v11
    v_sub_u32 v12, v10, v12
    v_mul_u32_u24 v11, 1280, v11
    v_lshl_add_u32 v15, v12, 4, v11
    buffer_load_dwordx4 v15, s[8:11], s35 offen lds
    s_add_u32 m0, m0, 1024
    v_add_u32 v10, 128, v2
    v_mul_u32_u24 v11, 205, v10
    v_lshrrev_b32 v11, 11, v11
    v_mul_u32_u24 v12, 10, v11
    v_sub_u32 v12, v10, v12
    v_mul_u32_u24 v11, 1280, v11
    v_lshl_add_u32 v16, v12, 4, v11
    buffer_load_dwordx4 v16, s[8:11], s35 offen lds
    s_add_u32 m0, m0, 1024
    v_add_u32 v10, 192, v2
    v_mul_u32_u24 v11, 205, v10
    v_lshrrev_b32 v11, 11, v11
    v_mul_u32_u24 v12, 10, v11
    v_sub_u32 v12, v10, v12
    v_mul_u32_u24 v11, 1280, v11
    v_lshl_add_u32 v17, v12, 4, v11
    buffer_load_dwordx4 v17, s[8:11], s35 offen lds
    s_add_u32 m0, m0, 1024
    v_add_u32 v10, 256, v2
    v_mul_u32_u24 v11, 205, v10
    v_lshrrev_b32 v11, 11, v11
    v_mul_u32_u24 v12, 10, v11
    v_sub_u32 v12, v10, v12
    v_mul_u32_u24 v11, 1280, v11
    v_lshl_add_u32 v18, v12, 4, v11
    buffer_load_dwordx4 v18, s[8:11], s35 offen lds
    v_mul_u32_u24 v5, 160, v9
    v_add_u32 v5, s29, v5
    v_lshl_add_u32 v5, v4, 3, v5
    v_add_u32 v13, 0x1000, v3
    s_waitcnt vmcnt(0)
    ds_read_b64_tr_b16 v[20:21], v5 offset:0
    ds_read_b64_tr_b16 v[22:23], v5 offset:2560
    ds_read_b64_tr_b16 v[24:25], v5 offset:32
    ds_read_b64_tr_b16 v[26:27], v5 offset:2592
    ds_read_b64_tr_b16 v[28:29], v5 offset:64
    ds_read_b64_tr_b16 v[30:31], v5 offset:2624
    ds_read_b64_tr_b16 v[32:33], v5 offset:96
    ds_read_b64_tr_b16 v[34:35], v5 offset:2656
    ds_read_b64_tr_b16 v[36:37], v5 offset:128
    ds_read_b64_tr_b16 v[38:39], v5 offset:2688
    s_waitcnt lgkmcnt(8)
    buffer_store_dwordx4 v[20:23], v3, s[12:15], s40 offen offset:0 sc1
    s_waitcnt lgkmcnt(6)
    buffer_store_dwordx4 v[24:27], v3, s[12:15], s40 offen offset:1024 sc1
    s_waitcnt lgkmcnt(4)
    buffer_store_dwordx4 v[28:31], v3, s[12:15], s40 offen offset:2048 sc1
    s_waitcnt lgkmcnt(2)
    buffer_store_dwordx4 v[32:35], v3, s[12:15], s40 offen offset:3072 sc1
    s_waitcnt lgkmcnt(0)
    buffer_store_dwordx4 v[36:39], v13, s[12:15], s40 offen sc1
    s_branch fnet_a_kernel_fin
fnet_a_kernel_zero:
    s_cmp_ge_u32 s22, 8
    s_cbranch_scc1 fnet_a_kernel_end
    s_waitcnt lgkmcnt(0)
    s_mov_b32 s14, 14323712
    s_mov_b32 s15, 0x20000
    v_lshlrev_b32 v3, 4, v0
    v_mov_b32 v4, 0
    v_mov_b32 v5, 0
    v_mov_b32 v6, 0
    v_mov_b32 v7, 0
    s_mov_b32 s30, 5263360
    buffer_store_dwordx4 v[4:7], v3, s[12:15], s30 offen
fnet_a_kernel_fin:
fnet_a_kernel_end:
    s_endpgm
.globl fnet_cd_kernel
.p2align 8
.type fnet_cd_kernel,@function
fnet_cd_kernel:
    s_cmp_ge_u32 s2, 256
    s_cbranch_scc1 fnet_cd_kernel_end
    s_load_dwordx2 s[8:9], s[0:1], 0
    s_load_dwordx2 s[12:13], s[0:1], 96
    s_load_dwordx2 s[16:17], s[0:1], 56
    s_load_dwordx4 s[4:7], s[0:1], 72
    v_lshrrev_b32 v1, 6, v0
    v_and_b32 v2, 63, v0
    v_readfirstlane_b32 s26, v1
    s_and_b32 s20, s2, 7
    s_lshr_b32 s21, s2, 3
    s_lshr_b32 s22, s20, 1
    s_lshl_b32 s22, s22, 3
    s_lshr_b32 s23, s21, 2
    s_add_u32 s22, s22, s23
    s_and_b32 s23, s20, 1
    s_lshl_b32 s23, s23, 2
    s_and_b32 s21, s21, 3
    s_add_u32 s23, s23, s21
    s_lshr_b32 s24, s22, 1
    s_sub_u32 s25, 32, s24
    s_cmp_eq_u32 s22, 1
    s_cselect_b32 s25, 16, s25
    s_bitcmp1_b32 s22, 0
    s_cselect_b32 s24, s25, s24
    v_lshrrev_b32 v6, 3, v2
    v_xor_b32 v7, v6, v2
    v_and_b32 v7, 7, v7
    v_mul_u32_u24 v6, 0xa000, v6
    v_lshl_add_u32 v6, v7, 4, v6
    s_lshl_b32 s32, s26, 9
    s_add_u32 s32, s32, s24
    s_mul_i32 s32, s32, 1280
    s_add_u32 s33, s32, 327680
    s_lshl_b32 s27, s26, 11
    s_sub_u32 s25, 32, s24
    s_and_b32 s25, s25, 31
    s_mul_i32 s34, s26, 2560
    s_add_u32 s35, s34, 240
    s_sub_u32 s34, 10240, s34
    s_cmp_lt_u32 s26, 2
    s_cselect_b64 vcc, -1, 0
    s_cselect_b32 s28, 1, -1
    s_cselect_b32 s30, s24, s25
    s_cselect_b32 s38, 0, 0x80000000
    s_cselect_b32 s39, 0, 1
    s_cselect_b32 s35, s35, s34
    s_lshl_b32 s28, s28, 8
    s_or_b32 s38, s38, 0x3a000000
    s_cmp_eq_u32 s24, 0
    s_cselect_b32 s39, 0, s39
    s_mul_i32 s31, s30, 40960
    s_add_u32 s31, s31, s35
    s_lshl_b32 s36, s23, 2
    s_add_u32 s36, s36, s26
    s_mul_i32 s37, s36, 61440
    s_add_u32 s58, s37, 3280896
    s_add_u32 s37, s37, 1314816
    s_add_u32 s29, s37, 40960
    s_waitcnt lgkmcnt(0)
    s_mov_b32 s10, 2621440
    s_mov_b32 s11, 0x20000
    s_add_u32 m0, s27, 0
    s_nop 0
    buffer_load_dwordx4 v6, s[8:11], s32 offen offset:0 lds
    s_add_u32 m0, s27, 1024
    s_nop 0
    buffer_load_dwordx4 v6, s[8:11], s33 offen offset:0 lds
    s_add_u32 m0, s27, 8064
    s_nop 0
    buffer_load_dwordx4 v6, s[8:11], s32 offen offset:128 lds
    s_add_u32 m0, s27, 9088
    s_nop 0
    buffer_load_dwordx4 v6, s[8:11], s33 offen offset:128 lds
    s_mov_b32 s14, 14323712
    s_add_u32 m0, s27, 16128
    s_nop 0
    buffer_load_dwordx4 v6, s[8:11], s32 offen offset:256 lds
    s_mov_b32 s15, 0x20000
    s_add_u32 m0, s27, 17152
    s_nop 0
    buffer_load_dwordx4 v6, s[8:11], s33 offen offset:256 lds
    s_mov_b32 s18, 3072
    s_add_u32 m0, s27, 24192
    s_nop 0
    buffer_load_dwordx4 v6, s[8:11], s32 offen offset:384 lds
    s_mov_b32 s19, 0x20000
    s_add_u32 m0, s27, 25216
    s_nop 0
    buffer_load_dwordx4 v6, s[8:11], s33 offen offset:384 lds
    s_mov_b32 s80, s4
    s_add_u32 m0, s27, 32256
    s_nop 0
    buffer_load_dwordx4 v6, s[8:11], s32 offen offset:512 lds
    s_mov_b32 s81, s5
    s_mov_b32 s82, 1280
    s_mov_b32 s83, 0x20000
    s_mov_b32 s84, s6
    s_mov_b32 s85, s7
    s_mov_b32 s86, 2621440
    s_mov_b32 s87, 0x20000
    v_and_b32 v3, 15, v2
    v_lshrrev_b32 v4, 4, v2
    v_lshlrev_b32 v5, 4, v2
    v_sub_u32 v11, 15, v3
    v_cndmask_b32 v10, v11, v3, vcc
    v_mul_u32_u24 v11, 5120, v4
    v_lshl_add_u32 v10, v10, 4, v11
    v_add_u32 v11, 0x5000, v10
    v_and_b32 v12, 0xcf, v0
    v_cmp_eq_u32 vcc, 0, v12
    v_mov_b32 v14, 0x7ff00000
    s_nop 0
    v_cndmask_b32 v12, v10, v14, vcc
    v_cndmask_b32 v13, v11, v14, vcc
    v_xor_b32 v7, v4, v3
    v_and_b32 v7, 7, v7
    v_lshlrev_b32 v7, 4, v7
    v_lshl_add_u32 v7, v3, 7, v7
    v_xor_b32 v8, 64, v7
    v_add_u32 v24, 0xa000, v7
    v_add_u32 v25, 0xa000, v8
    s_mul_i32 s40, s26, 5
    s_lshr_b32 s41, s40, 1
    s_lshl_b32 s41, s41, 13
    s_and_b32 s42, s26, 1
    s_lshl_b32 s43, s42, 6
    s_lshl_b32 s42, s42, 13
    s_add_u32 s42, s42, s41
    v_xor_b32 v26, s43, v7
    v_add_u32 v26, s41, v26
    v_xor_b32 v27, s43, v8
    v_add_u32 v27, s42, v27
    v_and_b32 v28, 1, v3
    v_lshlrev_b32 v28, 4, v28
    v_mov_b32 v29, 0x3f80
    v_lshlrev_b32 v28, v28, v29
    v_lshrrev_b32 v29, 1, v3
    v_lshlrev_b32 v30, 2, v4
    v_sub_u32 v29, v29, v30
    v_cmp_eq_u32 vcc, 0, v29
    v_cmp_eq_u32 s[44:45], -8, v29
    s_nop 0
    v_cndmask_b32 v16, 0, v28, vcc
    v_cndmask_b32 v20, 0, v28, s[44:45]
    v_cmp_eq_u32 vcc, 1, v29
    v_cmp_eq_u32 s[44:45], -7, v29
    s_nop 0
    v_cndmask_b32 v17, 0, v28, vcc
    v_cndmask_b32 v21, 0, v28, s[44:45]
    v_cmp_eq_u32 vcc, 2, v29
    v_cmp_eq_u32 s[44:45], -6, v29
    s_nop 0
    v_cndmask_b32 v18, 0, v28, vcc
    v_cndmask_b32 v22, 0, v28, s[44:45]
    v_cmp_eq_u32 vcc, 3, v29
    v_cmp_eq_u32 s[44:45], -5, v29
    s_nop 0
    v_cndmask_b32 v19, 0, v28, vcc
    v_cndmask_b32 v23, 0, v28, s[44:45]
    v_lshlrev_b32 v14, 5, v3
    v_add_u32 v14, s24, v14
    v_lshlrev_b32 v15, 1, v4
    v_cvt_f32_u32 v15, v15
    v_xor_b32 v28, s39, v3
    v_lshlrev_b32 v28, 31, v28
    v_or_b32 v28, 0x38003800, v28
    v_cmp_eq_u32 vcc, 0, v4
    v_add_u32 v29, 0, v14
    v_cvt_f32_u32 v29, v29
    v_mul_f32 v29, s38, v29
    v_mul_f32 v64, v29, v15
    v_sub_f32 v30, 0, v64
    v_fmamk_f32 v65, v29, 0x42000000, v30
    v_fmamk_f32 v66, v29, 0x3f800000, v64
    v_fmamk_f32 v67, v29, 0x41f80000, v30
    v_fmamk_f32 v68, v29, 0x41000000, v64
    v_fmamk_f32 v69, v29, 0x41c00000, v30
    v_fmamk_f32 v70, v29, 0x41100000, v64
    v_fmamk_f32 v71, v29, 0x41b80000, v30
    v_mul_f32 v31, 0x41800000, v29
    v_cndmask_b32 v65, v65, v31, vcc
    v_sin_f32 v72, v64
    v_sin_f32 v73, v65
    v_sin_f32 v74, v66
    v_sin_f32 v75, v67
    v_sin_f32 v76, v68
    v_sin_f32 v77, v69
    v_sin_f32 v78, v70
    v_sin_f32 v79, v71
    v_cos_f32 v64, v64
    v_cos_f32 v65, v65
    v_cos_f32 v66, v66
    s_add_u32 m0, s27, 33280
    s_nop 0
    buffer_load_dwordx4 v6, s[8:11], s33 offen offset:512 lds
    v_cos_f32 v67, v67
    v_cos_f32 v68, v68
    v_cos_f32 v69, v69
    v_cos_f32 v70, v70
    v_cos_f32 v71, v71
    v_cvt_pk_f16_f32 v32, v64, v72
    v_cvt_pk_f16_f32 v33, v65, v73
    v_cvt_pk_f16_f32 v34, v66, v74
    v_cvt_pk_f16_f32 v35, v67, v75
    v_cvt_pk_f16_f32 v36, v68, v76
    s_add_u32 m0, s27, 40320
    s_nop 0
    buffer_load_dwordx4 v6, s[8:11], s32 offen offset:640 lds
    v_cvt_pk_f16_f32 v37, v69, v77
    v_cvt_pk_f16_f32 v38, v70, v78
    v_cvt_pk_f16_f32 v39, v71, v79
    v_cndmask_b32 v32, v32, v28, vcc
    v_add_u32 v29, 512, v14
    v_cvt_f32_u32 v29, v29
    v_mul_f32 v29, s38, v29
    v_mul_f32 v64, v29, v15
    v_sub_f32 v30, 0, v64
    v_fmamk_f32 v65, v29, 0x42000000, v30
    v_fmamk_f32 v66, v29, 0x3f800000, v64
    v_fmamk_f32 v67, v29, 0x41f80000, v30
    v_fmamk_f32 v68, v29, 0x41000000, v64
    v_fmamk_f32 v69, v29, 0x41c00000, v30
    s_add_u32 m0, s27, 41344
    s_nop 0
    buffer_load_dwordx4 v6, s[8:11], s33 offen offset:640 lds
    v_fmamk_f32 v70, v29, 0x41100000, v64
    v_fmamk_f32 v71, v29, 0x41b80000, v30
    v_mul_f32 v31, 0x41800000, v29
    v_cndmask_b32 v65, v65, v31, vcc
    v_sin_f32 v72, v64
    v_sin_f32 v73, v65
    v_sin_f32 v74, v66
    v_sin_f32 v75, v67
    v_sin_f32 v76, v68
    v_sin_f32 v77, v69
    s_add_u32 m0, s27, 48384
    s_nop 0
    buffer_load_dwordx4 v6, s[8:11], s32 offen offset:768 lds
    v_sin_f32 v78, v70
    v_sin_f32 v79, v71
    v_cos_f32 v64, v64
    v_cos_f32 v65, v65
    v_cos_f32 v66, v66
    v_cos_f32 v67, v67
    v_cos_f32 v68, v68
    v_cos_f32 v69, v69
    s_add_u32 m0, s27, 49408
    s_nop 0
    buffer_load_dwordx4 v6, s[8:11], s33 offen offset:768 lds
    v_cos_f32 v70, v70
    v_cos_f32 v71, v71
    v_cvt_pk_f16_f32 v40, v64, v72
    v_cvt_pk_f16_f32 v41, v65, v73
    v_cvt_pk_f16_f32 v42, v66, v74
    v_cvt_pk_f16_f32 v43, v67, v75
    v_cvt_pk_f16_f32 v44, v68, v76
    v_cvt_pk_f16_f32 v45, v69, v77
    v_cvt_pk_f16_f32 v46, v70, v78
    v_cvt_pk_f16_f32 v47, v71, v79
    v_cndmask_b32 v40, v40, v28, vcc
    v_add_u32 v29, 1024, v14
    v_cvt_f32_u32 v29, v29
    s_add_u32 m0, s27, 56448
    s_nop 0
    buffer_load_dwordx4 v6, s[8:11], s32 offen offset:896 lds
    v_mul_f32 v29, s38, v29
    v_mul_f32 v64, v29, v15
    v_sub_f32 v30, 0, v64
    v_fmamk_f32 v65, v29, 0x42000000, v30
    v_fmamk_f32 v66, v29, 0x3f800000, v64
    v_fmamk_f32 v67, v29, 0x41f80000, v30
    v_fmamk_f32 v68, v29, 0x41000000, v64
    v_fmamk_f32 v69, v29, 0x41c00000, v30
    v_fmamk_f32 v70, v29, 0x41100000, v64
    v_fmamk_f32 v71, v29, 0x41b80000, v30
    v_mul_f32 v31, 0x41800000, v29
    v_cndmask_b32 v65, v65, v31, vcc
    v_sin_f32 v72, v64
    s_add_u32 m0, s27, 57472
    s_nop 0
    buffer_load_dwordx4 v6, s[8:11], s33 offen offset:896 lds
    v_sin_f32 v73, v65
    v_sin_f32 v74, v66
    v_sin_f32 v75, v67
    v_sin_f32 v76, v68
    v_sin_f32 v77, v69
    v_sin_f32 v78, v70
    v_sin_f32 v79, v71
    v_cos_f32 v64, v64
    v_cos_f32 v65, v65
    s_add_u32 m0, s27, 64512
    s_nop 0
    buffer_load_dwordx4 v6, s[8:11], s32 offen offset:1024 lds
    v_cos_f32 v66, v66
    v_cos_f32 v67, v67
    v_cos_f32 v68, v68
    v_cos_f32 v69, v69
    v_cos_f32 v70, v70
    v_cos_f32 v71, v71
    v_cvt_pk_f16_f32 v48, v64, v72
    v_cvt_pk_f16_f32 v49, v65, v73
    v_cvt_pk_f16_f32 v50, v66, v74
    s_add_u32 m0, s27, 65536
    s_nop 0
    buffer_load_dwordx4 v6, s[8:11], s33 offen offset:1024 lds
    v_cvt_pk_f16_f32 v51, v67, v75
    v_cvt_pk_f16_f32 v52, v68, v76
    v_cvt_pk_f16_f32 v53, v69, v77
    v_cvt_pk_f16_f32 v54, v70, v78
    v_cvt_pk_f16_f32 v55, v71, v79
    v_cndmask_b32 v48, v48, v28, vcc
    v_add_u32 v29, 1536, v14
    v_cvt_f32_u32 v29, v29
    v_mul_f32 v29, s38, v29
    v_mul_f32 v64, v29, v15
    v_sub_f32 v30, 0, v64
    v_fmamk_f32 v65, v29, 0x42000000, v30
    v_fmamk_f32 v66, v29, 0x3f800000, v64
    v_fmamk_f32 v67, v29, 0x41f80000, v30
    s_add_u32 m0, s27, 72576
    s_nop 0
    buffer_load_dwordx4 v6, s[8:11], s32 offen offset:1152 lds
    v_fmamk_f32 v68, v29, 0x41000000, v64
    v_fmamk_f32 v69, v29, 0x41c00000, v30
    v_fmamk_f32 v70, v29, 0x41100000, v64
    v_fmamk_f32 v71, v29, 0x41b80000, v30
    v_mul_f32 v31, 0x41800000, v29
    v_cndmask_b32 v65, v65, v31, vcc
    v_sin_f32 v72, v64
    v_sin_f32 v73, v65
    v_sin_f32 v74, v66
    v_sin_f32 v75, v67
    v_sin_f32 v76, v68
    s_add_u32 m0, s27, 73600
    s_nop 0
    buffer_load_dwordx4 v6, s[8:11], s33 offen offset:1152 lds
    v_sin_f32 v77, v69
    v_sin_f32 v78, v70
    v_sin_f32 v79, v71
    v_cos_f32 v64, v64
    v_cos_f32 v65, v65
    v_cos_f32 v66, v66
    v_cos_f32 v67, v67
    v_cos_f32 v68, v68
    buffer_load_dwordx4 a[0:3], v12, s[12:15], s31 offen
    v_cos_f32 v69, v69
    v_cos_f32 v70, v70
    v_cos_f32 v71, v71
    v_cvt_pk_f16_f32 v56, v64, v72
    v_cvt_pk_f16_f32 v57, v65, v73
    v_cvt_pk_f16_f32 v58, v66, v74
    v_cvt_pk_f16_f32 v59, v67, v75
    v_cvt_pk_f16_f32 v60, v68, v76
    v_cvt_pk_f16_f32 v61, v69, v77
    v_cvt_pk_f16_f32 v62, v70, v78
    v_cvt_pk_f16_f32 v63, v71, v79
    v_cndmask_b32 v56, v56, v28, vcc
    buffer_load_dwordx4 a[4:7], v13, s[12:15], s31 offen
    s_add_u32 s31, s31, s28
    buffer_load_dwordx4 a[8:11], v10, s[12:15], s31 offen
    buffer_load_dwordx4 a[12:15], v11, s[12:15], s31 offen
    s_add_u32 s31, s31, s28
    buffer_load_dwordx4 a[16:19], v10, s[12:15], s31 offen
    buffer_load_dwordx4 a[20:23], v11, s[12:15], s31 offen
    s_add_u32 s31, s31, s28
    buffer_load_dwordx4 a[24:27], v10, s[12:15], s31 offen
    buffer_load_dwordx4 a[28:31], v11, s[12:15], s31 offen
    s_add_u32 s31, s31, s28
    s_waitcnt vmcnt(8)
    s_barrier
    ds_read_b128 v[224:227], v26 offset:0
    buffer_load_dwordx4 a[32:35], v10, s[12:15], s31 offen
    ds_read_b128 v[228:231], v26 offset:2048
    ds_read_b128 v[232:235], v26 offset:4096
    ds_read_b128 v[236:239], v26 offset:6144
    ds_read_b128 v[240:243], v27 offset:0
    ds_read_b128 v[244:247], v27 offset:2048
    ds_read_b128 v[248:251], v27 offset:4096
    ds_read_b128 v[252:255], v27 offset:6144
    s_waitcnt lgkmcnt(4)
    v_mfma_f32_16x16x32_bf16 v[64:67], v[16:19], v[224:227], 0
    buffer_load_dwordx4 a[36:39], v11, s[12:15], s31 offen
    s_add_u32 s31, s31, s28
    v_mfma_f32_16x16x32_bf16 v[68:71], v[20:23], v[224:227], 0
    buffer_load_dwordx4 a[40:43], v10, s[12:15], s31 offen
    v_mfma_f32_16x16x32_bf16 v[72:75], v[16:19], v[228:231], 0
    v_mfma_f32_16x16x32_bf16 v[76:79], v[20:23], v[228:231], 0
    v_mfma_f32_16x16x32_bf16 v[80:83], v[16:19], v[232:235], 0
    buffer_load_dwordx4 a[44:47], v11, s[12:15], s31 offen
    s_add_u32 s31, s31, s28
    v_mfma_f32_16x16x32_bf16 v[84:87], v[20:23], v[232:235], 0
    v_mfma_f32_16x16x32_bf16 v[88:91], v[16:19], v[236:239], 0
    v_mfma_f32_16x16x32_bf16 v[92:95], v[20:23], v[236:239], 0
    ds_read_b128 v[224:227], v26 offset:8192
    ds_read_b128 v[228:231], v26 offset:10240
    buffer_load_dwordx4 a[48:51], v10, s[12:15], s31 offen
    ds_read_b128 v[232:235], v26 offset:12288
    ds_read_b128 v[236:239], v26 offset:14336
    s_waitcnt lgkmcnt(4)
    v_mfma_f32_16x16x32_bf16 v[96:99], v[16:19], v[240:243], 0
    v_mfma_f32_16x16x32_bf16 v[100:103], v[20:23], v[240:243], 0
    v_mfma_f32_16x16x32_bf16 v[104:107], v[16:19], v[244:247], 0
    v_mfma_f32_16x16x32_bf16 v[108:111], v[20:23], v[244:247], 0
    buffer_load_dwordx4 a[52:55], v11, s[12:15], s31 offen
    s_add_u32 s31, s31, s28
    v_mfma_f32_16x16x32_bf16 v[112:115], v[16:19], v[248:251], 0
    v_mfma_f32_16x16x32_bf16 v[116:119], v[20:23], v[248:251], 0
    v_mfma_f32_16x16x32_bf16 v[120:123], v[16:19], v[252:255], 0
    v_mfma_f32_16x16x32_bf16 v[124:127], v[20:23], v[252:255], 0
    ds_read_b128 v[240:243], v27 offset:8192
    buffer_load_dwordx4 a[56:59], v10, s[12:15], s31 offen
    ds_read_b128 v[244:247], v27 offset:10240
    ds_read_b128 v[248:251], v27 offset:12288
    ds_read_b128 v[252:255], v27 offset:14336
    s_waitcnt lgkmcnt(4)
    v_mfma_f32_16x16x32_bf16 v[128:131], v[16:19], v[224:227], 0
    v_mfma_f32_16x16x32_bf16 v[132:135], v[20:23], v[224:227], 0
    v_mfma_f32_16x16x32_bf16 v[136:139], v[16:19], v[228:231], 0
    v_mfma_f32_16x16x32_bf16 v[140:143], v[20:23], v[228:231], 0
    buffer_load_dwordx4 a[60:63], v11, s[12:15], s31 offen
    s_add_u32 s31, s31, s28
    v_mfma_f32_16x16x32_bf16 v[144:147], v[16:19], v[232:235], 0
    v_mfma_f32_16x16x32_bf16 v[148:151], v[20:23], v[232:235], 0
    v_mfma_f32_16x16x32_bf16 v[152:155], v[16:19], v[236:239], 0
    v_mfma_f32_16x16x32_bf16 v[156:159], v[20:23], v[236:239], 0
    buffer_load_dwordx4 a[64:67], v10, s[12:15], s31 offen
    ds_read_b128 v[224:227], v26 offset:16384
    ds_read_b128 v[228:231], v26 offset:18432
    ds_read_b128 v[232:235], v26 offset:20480
    ds_read_b128 v[236:239], v26 offset:22528
    s_waitcnt lgkmcnt(4)
    v_mfma_f32_16x16x32_bf16 v[160:163], v[16:19], v[240:243], 0
    v_mfma_f32_16x16x32_bf16 v[164:167], v[20:23], v[240:243], 0
    v_mfma_f32_16x16x32_bf16 v[168:171], v[16:19], v[244:247], 0
    buffer_load_dwordx4 a[68:71], v11, s[12:15], s31 offen
    s_add_u32 s31, s31, s28
    v_mfma_f32_16x16x32_bf16 v[172:175], v[20:23], v[244:247], 0
    v_mfma_f32_16x16x32_bf16 v[176:179], v[16:19], v[248:251], 0
    v_mfma_f32_16x16x32_bf16 v[180:183], v[20:23], v[248:251], 0
    v_mfma_f32_16x16x32_bf16 v[184:187], v[16:19], v[252:255], 0
    v_mfma_f32_16x16x32_bf16 v[188:191], v[20:23], v[252:255], 0
    buffer_load_dwordx4 a[72:75], v10, s[12:15], s31 offen
    s_waitcnt lgkmcnt(0)
    v_mfma_f32_16x16x32_bf16 v[192:195], v[16:19], v[224:227], 0
    v_mfma_f32_16x16x32_bf16 v[196:199], v[20:23], v[224:227], 0
    v_mfma_f32_16x16x32_bf16 v[200:203], v[16:19], v[228:231], 0
    v_mfma_f32_16x16x32_bf16 v[204:207], v[20:23], v[228:231], 0
    v_mfma_f32_16x16x32_bf16 v[208:211], v[16:19], v[232:235], 0
    buffer_load_dwordx4 a[76:79], v11, s[12:15], s31 offen
    v_mfma_f32_16x16x32_bf16 v[212:215], v[20:23], v[232:235], 0
    v_mfma_f32_16x16x32_bf16 v[216:219], v[16:19], v[236:239], 0
    v_mfma_f32_16x16x32_bf16 v[220:223], v[20:23], v[236:239], 0
    s_waitcnt vmcnt(16)
    v_mfma_f32_16x16x32_f16 v[64:67], a[0:3], v[32:35], v[64:67]
    v_mfma_f32_16x16x32_f16 v[68:71], a[8:11], v[32:35], v[68:71]
    buffer_load_dwordx4 a[80:83], v5, s[12:15], s37 offen offset:0
    v_mfma_f32_16x16x32_f16 v[72:75], a[0:3], v[40:43], v[72:75]
    v_mfma_f32_16x16x32_f16 v[76:79], a[8:11], v[40:43], v[76:79]
    v_mfma_f32_16x16x32_f16 v[80:83], a[0:3], v[48:51], v[80:83]
    v_mfma_f32_16x16x32_f16 v[84:87], a[8:11], v[48:51], v[84:87]
    v_mfma_f32_16x16x32_f16 v[88:91], a[0:3], v[56:59], v[88:91]
    buffer_load_dwordx4 a[84:87], v5, s[12:15], s37 offen offset:1024
    v_mfma_f32_16x16x32_f16 v[92:95], a[8:11], v[56:59], v[92:95]
    v_mfma_f32_16x16x32_f16 v[64:67], a[4:7], v[36:39], v[64:67]
    v_mfma_f32_16x16x32_f16 v[68:71], a[12:15], v[36:39], v[68:71]
    v_mfma_f32_16x16x32_f16 v[72:75], a[4:7], v[44:47], v[72:75]
    v_mfma_f32_16x16x32_f16 v[76:79], a[12:15], v[44:47], v[76:79]
    buffer_load_dwordx4 a[88:91], v5, s[12:15], s29 offen offset:0
    v_mfma_f32_16x16x32_f16 v[80:83], a[4:7], v[52:55], v[80:83]
    v_mfma_f32_16x16x32_f16 v[84:87], a[12:15], v[52:55], v[84:87]
    v_mfma_f32_16x16x32_f16 v[88:91], a[4:7], v[60:63], v[88:91]
    v_mfma_f32_16x16x32_f16 v[92:95], a[12:15], v[60:63], v[92:95]
    s_waitcnt vmcnt(15)
    v_mfma_f32_16x16x32_f16 v[96:99], a[16:19], v[32:35], v[96:99]
    buffer_load_dwordx4 a[92:95], v5, s[12:15], s37 offen offset:2048
    v_mfma_f32_16x16x32_f16 v[100:103], a[24:27], v[32:35], v[100:103]
    v_mfma_f32_16x16x32_f16 v[104:107], a[16:19], v[40:43], v[104:107]
    v_cvt_pk_bf16_f32 v64, v64, v65
    v_cvt_pk_bf16_f32 v65, v66, v67
    v_mfma_f32_16x16x32_f16 v[108:111], a[24:27], v[40:43], v[108:111]
    v_cvt_pk_bf16_f32 v66, v68, v69
    v_cvt_pk_bf16_f32 v67, v70, v71
    v_mfma_f32_16x16x32_f16 v[112:115], a[16:19], v[48:51], v[112:115]
    buffer_load_dwordx4 a[96:99], v5, s[12:15], s37 offen offset:3072
    s_add_u32 s37, s37, 4096
    ds_write_b128 v26, v[64:67] offset:0
    v_cvt_pk_bf16_f32 v72, v72, v73
    v_mfma_f32_16x16x32_f16 v[116:119], a[24:27], v[48:51], v[116:119]
    v_cvt_pk_bf16_f32 v73, v74, v75
    v_cvt_pk_bf16_f32 v74, v76, v77
    v_mfma_f32_16x16x32_f16 v[120:123], a[16:19], v[56:59], v[120:123]
    v_cvt_pk_bf16_f32 v75, v78, v79
    ds_write_b128 v26, v[72:75] offset:2048
    buffer_load_dwordx4 a[100:103], v5, s[12:15], s29 offen offset:1024
    v_mfma_f32_16x16x32_f16 v[124:127], a[24:27], v[56:59], v[124:127]
    v_cvt_pk_bf16_f32 v80, v80, v81
    v_cvt_pk_bf16_f32 v81, v82, v83
    v_mfma_f32_16x16x32_f16 v[96:99], a[20:23], v[36:39], v[96:99]
    v_cvt_pk_bf16_f32 v82, v84, v85
    v_cvt_pk_bf16_f32 v83, v86, v87
    v_mfma_f32_16x16x32_f16 v[100:103], a[28:31], v[36:39], v[100:103]
    ds_write_b128 v26, v[80:83] offset:4096
    buffer_load_dwordx4 a[104:107], v5, s[12:15], s37 offen offset:0
    v_cvt_pk_bf16_f32 v88, v88, v89
    v_mfma_f32_16x16x32_f16 v[104:107], a[20:23], v[44:47], v[104:107]
    v_cvt_pk_bf16_f32 v89, v90, v91
    v_cvt_pk_bf16_f32 v90, v92, v93
    v_mfma_f32_16x16x32_f16 v[108:111], a[28:31], v[44:47], v[108:111]
    v_cvt_pk_bf16_f32 v91, v94, v95
    ds_write_b128 v26, v[88:91] offset:6144
    buffer_load_dwordx4 a[108:111], v5, s[12:15], s37 offen offset:1024
    v_mfma_f32_16x16x32_f16 v[112:115], a[20:23], v[52:55], v[112:115]
    v_mfma_f32_16x16x32_f16 v[116:119], a[28:31], v[52:55], v[116:119]
    v_mfma_f32_16x16x32_f16 v[120:123], a[20:23], v[60:63], v[120:123]
    v_mfma_f32_16x16x32_f16 v[124:127], a[28:31], v[60:63], v[124:127]
    s_waitcnt vmcnt(16)
    v_mfma_f32_16x16x32_f16 v[128:131], a[32:35], v[32:35], v[128:131]
    buffer_load_dwordx4 a[112:115], v5, s[12:15], s29 offen offset:2048
    v_mfma_f32_16x16x32_f16 v[132:135], a[40:43], v[32:35], v[132:135]
    v_mfma_f32_16x16x32_f16 v[136:139], a[32:35], v[40:43], v[136:139]
    v_cvt_pk_bf16_f32 v96, v96, v97
    v_cvt_pk_bf16_f32 v97, v98, v99
    v_mfma_f32_16x16x32_f16 v[140:143], a[40:43], v[40:43], v[140:143]
    v_cvt_pk_bf16_f32 v98, v100, v101
    v_cvt_pk_bf16_f32 v99, v102, v103
    v_mfma_f32_16x16x32_f16 v[144:147], a[32:35], v[48:51], v[144:147]
    ds_write_b128 v27, v[96:99] offset:0
    buffer_load_dwordx4 a[116:119], v5, s[12:15], s37 offen offset:2048
    v_cvt_pk_bf16_f32 v104, v104, v105
    v_mfma_f32_16x16x32_f16 v[148:151], a[40:43], v[48:51], v[148:151]
    v_cvt_pk_bf16_f32 v105, v106, v107
    v_cvt_pk_bf16_f32 v106, v108, v109
    v_mfma_f32_16x16x32_f16 v[152:155], a[32:35], v[56:59], v[152:155]
    v_cvt_pk_bf16_f32 v107, v110, v111
    ds_write_b128 v27, v[104:107] offset:2048
    buffer_load_dwordx4 a[120:123], v5, s[12:15], s37 offen offset:3072
    s_add_u32 s37, s37, 4096
    v_mfma_f32_16x16x32_f16 v[156:159], a[40:43], v[56:59], v[156:159]
    v_cvt_pk_bf16_f32 v112, v112, v113
    v_cvt_pk_bf16_f32 v113, v114, v115
    v_mfma_f32_16x16x32_f16 v[128:131], a[36:39], v[36:39], v[128:131]
    v_cvt_pk_bf16_f32 v114, v116, v117
    v_cvt_pk_bf16_f32 v115, v118, v119
    v_mfma_f32_16x16x32_f16 v[132:135], a[44:47], v[36:39], v[132:135]
    ds_write_b128 v27, v[112:115] offset:4096
    buffer_load_dwordx4 a[124:127], v5, s[12:15], s29 offen offset:3072
    s_add_u32 s29, s29, 4096
    v_cvt_pk_bf16_f32 v120, v120, v121
    v_mfma_f32_16x16x32_f16 v[136:139], a[36:39], v[44:47], v[136:139]
    v_cvt_pk_bf16_f32 v121, v122, v123
    v_cvt_pk_bf16_f32 v122, v124, v125
    v_mfma_f32_16x16x32_f16 v[140:143], a[44:47], v[44:47], v[140:143]
    v_cvt_pk_bf16_f32 v123, v126, v127
    ds_write_b128 v27, v[120:123] offset:6144
    v_mfma_f32_16x16x32_f16 v[144:147], a[36:39], v[52:55], v[144:147]
    buffer_load_dwordx4 a[128:131], v5, s[12:15], s37 offen offset:0
    v_mfma_f32_16x16x32_f16 v[148:151], a[44:47], v[52:55], v[148:151]
    v_mfma_f32_16x16x32_f16 v[152:155], a[36:39], v[60:63], v[152:155]
    v_mfma_f32_16x16x32_f16 v[156:159], a[44:47], v[60:63], v[156:159]
    s_waitcnt vmcnt(17)
    v_mfma_f32_16x16x32_f16 v[160:163], a[48:51], v[32:35], v[160:163]
    v_mfma_f32_16x16x32_f16 v[164:167], a[56:59], v[32:35], v[164:167]
    buffer_load_dwordx4 a[132:135], v5, s[12:15], s37 offen offset:1024
    v_mfma_f32_16x16x32_f16 v[168:171], a[48:51], v[40:43], v[168:171]
    v_cvt_pk_bf16_f32 v128, v128, v129
    v_cvt_pk_bf16_f32 v129, v130, v131
    v_mfma_f32_16x16x32_f16 v[172:175], a[56:59], v[40:43], v[172:175]
    v_cvt_pk_bf16_f32 v130, v132, v133
    v_cvt_pk_bf16_f32 v131, v134, v135
    v_mfma_f32_16x16x32_f16 v[176:179], a[48:51], v[48:51], v[176:179]
    ds_write_b128 v26, v[128:131] offset:8192
    v_cvt_pk_bf16_f32 v136, v136, v137
    buffer_load_dwordx4 a[136:139], v5, s[12:15], s29 offen offset:0
    v_mfma_f32_16x16x32_f16 v[180:183], a[56:59], v[48:51], v[180:183]
    v_cvt_pk_bf16_f32 v137, v138, v139
    v_cvt_pk_bf16_f32 v138, v140, v141
    v_mfma_f32_16x16x32_f16 v[184:187], a[48:51], v[56:59], v[184:187]
    v_cvt_pk_bf16_f32 v139, v142, v143
    ds_write_b128 v26, v[136:139] offset:10240
    v_mfma_f32_16x16x32_f16 v[188:191], a[56:59], v[56:59], v[188:191]
    v_cvt_pk_bf16_f32 v144, v144, v145
    v_cvt_pk_bf16_f32 v145, v146, v147
    buffer_load_dwordx4 a[140:143], v5, s[12:15], s37 offen offset:2048
    v_mfma_f32_16x16x32_f16 v[160:163], a[52:55], v[36:39], v[160:163]
    v_cvt_pk_bf16_f32 v146, v148, v149
    v_cvt_pk_bf16_f32 v147, v150, v151
    v_mfma_f32_16x16x32_f16 v[164:167], a[60:63], v[36:39], v[164:167]
    ds_write_b128 v26, v[144:147] offset:12288
    v_cvt_pk_bf16_f32 v152, v152, v153
    v_mfma_f32_16x16x32_f16 v[168:171], a[52:55], v[44:47], v[168:171]
    v_cvt_pk_bf16_f32 v153, v154, v155
    v_cvt_pk_bf16_f32 v154, v156, v157
    buffer_load_dwordx4 a[144:147], v5, s[12:15], s37 offen offset:3072
    s_add_u32 s37, s37, 4096
    v_mfma_f32_16x16x32_f16 v[172:175], a[60:63], v[44:47], v[172:175]
    v_cvt_pk_bf16_f32 v155, v158, v159
    ds_write_b128 v26, v[152:155] offset:14336
    v_mfma_f32_16x16x32_f16 v[176:179], a[52:55], v[52:55], v[176:179]
    v_mfma_f32_16x16x32_f16 v[180:183], a[60:63], v[52:55], v[180:183]
    v_mfma_f32_16x16x32_f16 v[184:187], a[52:55], v[60:63], v[184:187]
    buffer_load_dwordx4 a[148:151], v5, s[12:15], s29 offen offset:1024
    v_mfma_f32_16x16x32_f16 v[188:191], a[60:63], v[60:63], v[188:191]
    s_waitcnt vmcnt(18)
    v_mfma_f32_16x16x32_f16 v[192:195], a[64:67], v[32:35], v[192:195]
    v_mfma_f32_16x16x32_f16 v[196:199], a[72:75], v[32:35], v[196:199]
    v_mfma_f32_16x16x32_f16 v[192:195], a[68:71], v[36:39], v[192:195]
    v_cvt_pk_bf16_f32 v160, v160, v161
    buffer_load_dwordx4 a[152:155], v5, s[12:15], s37 offen offset:0
    v_cvt_pk_bf16_f32 v161, v162, v163
    v_mfma_f32_16x16x32_f16 v[196:199], a[76:79], v[36:39], v[196:199]
    v_cvt_pk_bf16_f32 v162, v164, v165
    v_cvt_pk_bf16_f32 v163, v166, v167
    v_mfma_f32_16x16x32_f16 v[200:203], a[64:67], v[40:43], v[200:203]
    ds_write_b128 v27, v[160:163] offset:8192
    v_cvt_pk_bf16_f32 v168, v168, v169
    v_mfma_f32_16x16x32_f16 v[204:207], a[72:75], v[40:43], v[204:207]
    v_cvt_pk_bf16_f32 v169, v170, v171
    buffer_load_dwordx4 a[156:159], v5, s[12:15], s37 offen offset:1024
    v_cvt_pk_bf16_f32 v170, v172, v173
    v_mfma_f32_16x16x32_f16 v[200:203], a[68:71], v[44:47], v[200:203]
    v_cvt_pk_bf16_f32 v171, v174, v175
    ds_write_b128 v27, v[168:171] offset:10240
    v_mfma_f32_16x16x32_f16 v[204:207], a[76:79], v[44:47], v[204:207]
    v_cvt_pk_bf16_f32 v176, v176, v177
    v_cvt_pk_bf16_f32 v177, v178, v179
    v_mfma_f32_16x16x32_f16 v[208:211], a[64:67], v[48:51], v[208:211]
    v_cvt_pk_bf16_f32 v178, v180, v181
    buffer_load_dwordx4 a[160:163], v5, s[12:15], s29 offen offset:2048
    v_cvt_pk_bf16_f32 v179, v182, v183
    v_mfma_f32_16x16x32_f16 v[212:215], a[72:75], v[48:51], v[212:215]
    ds_write_b128 v27, v[176:179] offset:12288
    v_cvt_pk_bf16_f32 v184, v184, v185
    v_mfma_f32_16x16x32_f16 v[208:211], a[68:71], v[52:55], v[208:211]
    v_cvt_pk_bf16_f32 v185, v186, v187
    v_cvt_pk_bf16_f32 v186, v188, v189
    v_mfma_f32_16x16x32_f16 v[212:215], a[76:79], v[52:55], v[212:215]
    v_cvt_pk_bf16_f32 v187, v190, v191
    buffer_load_dwordx4 a[164:167], v5, s[12:15], s37 offen offset:2048
    ds_write_b128 v27, v[184:187] offset:14336
    v_mfma_f32_16x16x32_f16 v[216:219], a[64:67], v[56:59], v[216:219]
    v_mfma_f32_16x16x32_f16 v[220:223], a[72:75], v[56:59], v[220:223]
    v_mfma_f32_16x16x32_f16 v[216:219], a[68:71], v[60:63], v[216:219]
    v_mfma_f32_16x16x32_f16 v[220:223], a[76:79], v[60:63], v[220:223]
    buffer_load_dwordx4 a[168:171], v5, s[12:15], s37 offen offset:3072
    s_add_u32 s37, s37, 4096
    v_cvt_pk_bf16_f32 v192, v192, v193
    v_cvt_pk_bf16_f32 v193, v194, v195
    v_cvt_pk_bf16_f32 v194, v196, v197
    v_cvt_pk_bf16_f32 v195, v198, v199
    ds_write_b128 v26, v[192:195] offset:16384
    v_cvt_pk_bf16_f32 v200, v200, v201
    v_cvt_pk_bf16_f32 v201, v202, v203
    v_cvt_pk_bf16_f32 v202, v204, v205
    buffer_load_dwordx4 a[172:175], v5, s[12:15], s29 offen offset:3072
    s_add_u32 s29, s29, 4096
    v_cvt_pk_bf16_f32 v203, v206, v207
    ds_write_b128 v26, v[200:203] offset:18432
    v_cvt_pk_bf16_f32 v208, v208, v209
    v_cvt_pk_bf16_f32 v209, v210, v211
    v_cvt_pk_bf16_f32 v210, v212, v213
    v_cvt_pk_bf16_f32 v211, v214, v215
    ds_write_b128 v26, v[208:211] offset:20480
    buffer_load_dwordx4 a[176:179], v5, s[12:15], s37 offen offset:0
    v_cvt_pk_bf16_f32 v216, v216, v217
    v_cvt_pk_bf16_f32 v217, v218, v219
    v_cvt_pk_bf16_f32 v218, v220, v221
    v_cvt_pk_bf16_f32 v219, v222, v223
    ds_write_b128 v26, v[216:219] offset:22528
    s_waitcnt lgkmcnt(0)
    s_barrier
    ds_read_b128 v[32:35], v7 offset:0
    buffer_load_dwordx4 a[180:183], v5, s[12:15], s37 offen offset:1024
    ds_read_b128 v[36:39], v7 offset:2048
    buffer_load_dwordx4 a[184:187], v5, s[12:15], s29 offen offset:0
    ds_read_b128 v[40:43], v7 offset:4096
    ds_read_b128 v[44:47], v7 offset:6144
    v_mov_b32 v16, 0x3f803f80
    v_mov_b32 v17, 0x3f803f80
    v_mov_b32 v18, 0x3f803f80
    v_mov_b32 v19, 0x3f803f80
    s_mul_i32 s42, s23, 12
    s_lshl_b32 s43, s26, 1
    s_add_u32 s43, s43, s42
    buffer_load_dwordx4 a[188:191], v5, s[12:15], s37 offen offset:2048
    s_add_u32 s44, s42, 8
    s_add_u32 s44, s44, s26
    v_lshlrev_b32 v20, 3, v4
    v_lshlrev_b32 v21, 4, v4
    s_lshl_b32 s45, s43, 4
    s_lshl_b32 s46, s44, 4
    s_sub_u32 s46, s46, 32
    v_mov_b32 v12, s46
    v_mov_b32 v13, s45
    v_cmp_gt_u32 vcc, 32, v2
    s_mov_b32 s47, 5246976
    s_mov_b32 s48, 5253120
    s_mul_i32 s45, s23, 160
    v_cndmask_b32 v12, v12, v13, vcc
    v_add_u32 v12, v12, v2
    v_lshlrev_b32 v13, 1, v12
    buffer_load_dwordx4 a[192:195], v5, s[12:15], s37 offen offset:3072
    s_add_u32 s37, s37, 4096
    v_lshlrev_b32 v12, 2, v12
    v_lshlrev_b32 v14, 2, v2
    s_mul_i32 s49, s26, 768
    s_add_u32 s49, s49, 94208
    v_add_u32 v15, s49, v14
    v_add_u32 v21, s49, v21
    v_add_u32 v6, s49, v20
    v_mfma_f32_16x16x32_bf16 v[224:227], v[16:19], v[64:67], 0
    v_mfma_f32_16x16x32_bf16 v[240:243], v[64:67], v[64:67], 0
    v_mfma_f32_16x16x32_bf16 v[228:231], v[16:19], v[72:75], 0
    buffer_load_dwordx4 a[196:199], v5, s[12:15], s29 offen offset:1024
    v_mfma_f32_16x16x32_bf16 v[244:247], v[72:75], v[72:75], 0
    v_mfma_f32_16x16x32_bf16 v[232:235], v[16:19], v[80:83], 0
    v_mfma_f32_16x16x32_bf16 v[248:251], v[80:83], v[80:83], 0
    s_waitcnt vmcnt(27)
    s_waitcnt lgkmcnt(0)
    v_mfma_f32_16x16x32_bf16 v[68:71], a[80:83], v[32:35], 0
    ds_read_b128 v[48:51], v8 offset:0
    v_mfma_f32_16x16x32_bf16 v[76:79], a[80:83], v[36:39], 0
    buffer_load_dwordx4 a[200:203], v5, s[12:15], s37 offen offset:0
    ds_read_b128 v[52:55], v8 offset:2048
    v_mfma_f32_16x16x32_bf16 v[84:87], a[80:83], v[40:43], 0
    ds_read_b128 v[56:59], v8 offset:4096
    v_mfma_f32_16x16x32_bf16 v[92:95], a[80:83], v[44:47], 0
    ds_read_b128 v[60:63], v8 offset:6144
    v_mfma_f32_16x16x32_bf16 v[100:103], a[84:87], v[32:35], 0
    v_mfma_f32_16x16x32_bf16 v[108:111], a[84:87], v[36:39], 0
    v_mfma_f32_16x16x32_bf16 v[236:239], v[16:19], v[88:91], 0
    buffer_load_dwordx4 a[204:207], v5, s[12:15], s37 offen offset:1024
    v_mfma_f32_16x16x32_bf16 v[116:119], a[84:87], v[40:43], 0
    v_mfma_f32_16x16x32_bf16 v[124:127], a[84:87], v[44:47], 0
    v_mfma_f32_16x16x32_bf16 v[132:135], a[88:91], v[32:35], 0
    v_mfma_f32_16x16x32_bf16 v[252:255], v[88:91], v[88:91], 0
    v_mfma_f32_16x16x32_bf16 v[140:143], a[88:91], v[36:39], 0
    buffer_load_dwordx4 a[208:211], v5, s[12:15], s29 offen offset:2048
    v_mfma_f32_16x16x32_bf16 v[148:151], a[88:91], v[40:43], 0
    v_mfma_f32_16x16x32_bf16 v[156:159], a[88:91], v[44:47], 0
    v_mfma_f32_16x16x32_bf16 v[224:227], v[16:19], v[96:99], v[224:227]
    s_waitcnt vmcnt(27)
    s_waitcnt lgkmcnt(0)
    v_mfma_f32_16x16x32_bf16 v[68:71], a[92:95], v[48:51], v[68:71]
    ds_read_b128 v[32:35], v7 offset:8192
    buffer_load_dwordx4 a[212:215], v5, s[12:15], s37 offen offset:2048
    v_mfma_f32_16x16x32_bf16 v[76:79], a[92:95], v[52:55], v[76:79]
    ds_read_b128 v[36:39], v7 offset:10240
    v_mfma_f32_16x16x32_bf16 v[84:87], a[92:95], v[56:59], v[84:87]
    ds_read_b128 v[40:43], v7 offset:12288
    v_mfma_f32_16x16x32_bf16 v[92:95], a[92:95], v[60:63], v[92:95]
    ds_read_b128 v[44:47], v7 offset:14336
    v_mfma_f32_16x16x32_bf16 v[100:103], a[96:99], v[48:51], v[100:103]
    v_mfma_f32_16x16x32_bf16 v[108:111], a[96:99], v[52:55], v[108:111]
    buffer_load_dwordx4 a[216:219], v5, s[12:15], s37 offen offset:3072
    s_add_u32 s37, s37, 4096
    v_mfma_f32_16x16x32_bf16 v[240:243], v[96:99], v[96:99], v[240:243]
    v_mfma_f32_16x16x32_bf16 v[116:119], a[96:99], v[56:59], v[116:119]
    v_mfma_f32_16x16x32_bf16 v[124:127], a[96:99], v[60:63], v[124:127]
    v_mfma_f32_16x16x32_bf16 v[132:135], a[100:103], v[48:51], v[132:135]
    buffer_load_dwordx4 a[220:223], v5, s[12:15], s29 offen offset:3072
    s_add_u32 s29, s29, 4096
    v_mfma_f32_16x16x32_bf16 v[228:231], v[16:19], v[104:107], v[228:231]
    v_mfma_f32_16x16x32_bf16 v[140:143], a[100:103], v[52:55], v[140:143]
    v_mfma_f32_16x16x32_bf16 v[148:151], a[100:103], v[56:59], v[148:151]
    v_mfma_f32_16x16x32_bf16 v[156:159], a[100:103], v[60:63], v[156:159]
    buffer_load_dwordx4 a[224:227], v5, s[12:15], s37 offen offset:0
    v_mfma_f32_16x16x32_bf16 v[244:247], v[104:107], v[104:107], v[244:247]
    s_waitcnt vmcnt(28)
    s_waitcnt lgkmcnt(0)
    v_mfma_f32_16x16x32_bf16 v[68:71], a[104:107], v[32:35], v[68:71]
    ds_read_b128 v[48:51], v8 offset:8192
    v_mfma_f32_16x16x32_bf16 v[76:79], a[104:107], v[36:39], v[76:79]
    ds_read_b128 v[52:55], v8 offset:10240
    v_mfma_f32_16x16x32_bf16 v[84:87], a[104:107], v[40:43], v[84:87]
    ds_read_b128 v[56:59], v8 offset:12288
    buffer_load_dwordx4 a[228:231], v5, s[12:15], s37 offen offset:1024
    v_mfma_f32_16x16x32_bf16 v[92:95], a[104:107], v[44:47], v[92:95]
    ds_read_b128 v[60:63], v8 offset:14336
    v_mfma_f32_16x16x32_bf16 v[100:103], a[108:111], v[32:35], v[100:103]
    v_mfma_f32_16x16x32_bf16 v[108:111], a[108:111], v[36:39], v[108:111]
    v_mfma_f32_16x16x32_bf16 v[232:235], v[16:19], v[112:115], v[232:235]
    v_mfma_f32_16x16x32_bf16 v[116:119], a[108:111], v[40:43], v[116:119]
    buffer_load_dwordx4 a[232:235], v5, s[12:15], s29 offen offset:0
    v_mfma_f32_16x16x32_bf16 v[124:127], a[108:111], v[44:47], v[124:127]
    v_mfma_f32_16x16x32_bf16 v[132:135], a[112:115], v[32:35], v[132:135]
    v_mfma_f32_16x16x32_bf16 v[248:251], v[112:115], v[112:115], v[248:251]
    v_mfma_f32_16x16x32_bf16 v[140:143], a[112:115], v[36:39], v[140:143]
    buffer_load_dwordx4 a[236:239], v5, s[12:15], s37 offen offset:2048
    v_mfma_f32_16x16x32_bf16 v[148:151], a[112:115], v[40:43], v[148:151]
    v_mfma_f32_16x16x32_bf16 v[156:159], a[112:115], v[44:47], v[156:159]
    v_mfma_f32_16x16x32_bf16 v[236:239], v[16:19], v[120:123], v[236:239]
    s_waitcnt vmcnt(28)
    s_waitcnt lgkmcnt(0)
    v_mfma_f32_16x16x32_bf16 v[68:71], a[116:119], v[48:51], v[68:71]
    ds_read_b128 v[32:35], v7 offset:16384
    buffer_load_dwordx4 a[240:243], v5, s[12:15], s37 offen offset:3072
    s_add_u32 s37, s37, 4096
    v_mfma_f32_16x16x32_bf16 v[76:79], a[116:119], v[52:55], v[76:79]
    ds_read_b128 v[36:39], v7 offset:18432
    v_mfma_f32_16x16x32_bf16 v[84:87], a[116:119], v[56:59], v[84:87]
    ds_read_b128 v[40:43], v7 offset:20480
    v_mfma_f32_16x16x32_bf16 v[92:95], a[116:119], v[60:63], v[92:95]
    ds_read_b128 v[44:47], v7 offset:22528
    v_mfma_f32_16x16x32_bf16 v[100:103], a[120:123], v[48:51], v[100:103]
    buffer_load_dwordx4 a[244:247], v5, s[12:15], s29 offen offset:1024
    v_mfma_f32_16x16x32_bf16 v[108:111], a[120:123], v[52:55], v[108:111]
    v_mfma_f32_16x16x32_bf16 v[252:255], v[120:123], v[120:123], v[252:255]
    v_mfma_f32_16x16x32_bf16 v[116:119], a[120:123], v[56:59], v[116:119]
    v_mfma_f32_16x16x32_bf16 v[124:127], a[120:123], v[60:63], v[124:127]
    v_mfma_f32_16x16x32_bf16 v[132:135], a[124:127], v[48:51], v[132:135]
    buffer_load_dwordx4 a[248:251], v5, s[12:15], s37 offen offset:0
    v_mfma_f32_16x16x32_bf16 v[224:227], v[16:19], v[128:131], v[224:227]
    v_mfma_f32_16x16x32_bf16 v[140:143], a[124:127], v[52:55], v[140:143]
    v_mfma_f32_16x16x32_bf16 v[148:151], a[124:127], v[56:59], v[148:151]
    v_mfma_f32_16x16x32_bf16 v[156:159], a[124:127], v[60:63], v[156:159]
    buffer_load_dwordx4 a[252:255], v5, s[12:15], s37 offen offset:1024
    v_mfma_f32_16x16x32_bf16 v[240:243], v[128:131], v[128:131], v[240:243]
    s_waitcnt vmcnt(29)
    s_waitcnt lgkmcnt(0)
    v_mfma_f32_16x16x32_bf16 v[68:71], a[128:131], v[32:35], v[68:71]
    ds_read_b128 v[48:51], v8 offset:16384
    v_mfma_f32_16x16x32_bf16 v[76:79], a[128:131], v[36:39], v[76:79]
    ds_read_b128 v[52:55], v8 offset:18432
    v_mfma_f32_16x16x32_bf16 v[84:87], a[128:131], v[40:43], v[84:87]
    ds_read_b128 v[56:59], v8 offset:20480
    buffer_load_dwordx4 a[0:3], v5, s[12:15], s29 offen offset:2048
    v_mfma_f32_16x16x32_bf16 v[92:95], a[128:131], v[44:47], v[92:95]
    ds_read_b128 v[60:63], v8 offset:22528
    v_mfma_f32_16x16x32_bf16 v[100:103], a[132:135], v[32:35], v[100:103]
    v_mfma_f32_16x16x32_bf16 v[108:111], a[132:135], v[36:39], v[108:111]
    v_mfma_f32_16x16x32_bf16 v[228:231], v[16:19], v[136:139], v[228:231]
    v_mfma_f32_16x16x32_bf16 v[116:119], a[132:135], v[40:43], v[116:119]
    buffer_load_dword v212, v12, s[12:15], s47 offen
    v_mfma_f32_16x16x32_bf16 v[124:127], a[132:135], v[44:47], v[124:127]
    v_mfma_f32_16x16x32_bf16 v[132:135], a[136:139], v[32:35], v[132:135]
    v_mfma_f32_16x16x32_bf16 v[244:247], v[136:139], v[136:139], v[244:247]
    v_mfma_f32_16x16x32_bf16 v[140:143], a[136:139], v[36:39], v[140:143]
    buffer_load_dword v213, v12, s[12:15], s48 offen
    v_mfma_f32_16x16x32_bf16 v[148:151], a[136:139], v[40:43], v[148:151]
    v_mfma_f32_16x16x32_bf16 v[156:159], a[136:139], v[44:47], v[156:159]
    v_mfma_f32_16x16x32_bf16 v[232:235], v[16:19], v[144:147], v[232:235]
    s_waitcnt vmcnt(29)
    s_waitcnt lgkmcnt(0)
    v_mfma_f32_16x16x32_bf16 v[68:71], a[140:143], v[48:51], v[68:71]
    ds_read_b128 v[32:35], v7 offset:24576
    buffer_load_ushort v214, v13, s[16:19], 0 offen
    v_mfma_f32_16x16x32_bf16 v[76:79], a[140:143], v[52:55], v[76:79]
    ds_read_b128 v[36:39], v7 offset:26624
    v_mfma_f32_16x16x32_bf16 v[84:87], a[140:143], v[56:59], v[84:87]
    ds_read_b128 v[40:43], v7 offset:28672
    v_mfma_f32_16x16x32_bf16 v[92:95], a[140:143], v[60:63], v[92:95]
    ds_read_b128 v[44:47], v7 offset:30720
    v_mfma_f32_16x16x32_bf16 v[100:103], a[144:147], v[48:51], v[100:103]
    v_mfma_f32_16x16x32_bf16 v[108:111], a[144:147], v[52:55], v[108:111]
    buffer_load_dword v215, v14, s[80:83], s45 offen
    v_mfma_f32_16x16x32_bf16 v[248:251], v[144:147], v[144:147], v[248:251]
    v_mfma_f32_16x16x32_bf16 v[116:119], a[144:147], v[56:59], v[116:119]
    v_mfma_f32_16x16x32_bf16 v[124:127], a[144:147], v[60:63], v[124:127]
    v_mfma_f32_16x16x32_bf16 v[132:135], a[148:151], v[48:51], v[132:135]
    buffer_load_dwordx4 a[4:7], v5, s[12:15], s37 offen offset:2048
    v_mfma_f32_16x16x32_bf16 v[236:239], v[16:19], v[152:155], v[236:239]
    v_mfma_f32_16x16x32_bf16 v[140:143], a[148:151], v[52:55], v[140:143]
    v_mfma_f32_16x16x32_bf16 v[148:151], a[148:151], v[56:59], v[148:151]
    v_mfma_f32_16x16x32_bf16 v[156:159], a[148:151], v[60:63], v[156:159]
    v_mfma_f32_16x16x32_bf16 v[252:255], v[152:155], v[152:155], v[252:255]
    buffer_load_dwordx4 a[8:11], v5, s[12:15], s37 offen offset:3072
    s_add_u32 s37, s37, 4096
    s_waitcnt vmcnt(30)
    s_waitcnt lgkmcnt(0)
    v_mfma_f32_16x16x32_bf16 v[68:71], a[152:155], v[32:35], v[68:71]
    ds_read_b128 v[48:51], v8 offset:24576
    v_mfma_f32_16x16x32_bf16 v[76:79], a[152:155], v[36:39], v[76:79]
    ds_read_b128 v[52:55], v8 offset:26624
    v_mfma_f32_16x16x32_bf16 v[84:87], a[152:155], v[40:43], v[84:87]
    ds_read_b128 v[56:59], v8 offset:28672
    buffer_load_dwordx4 a[12:15], v5, s[12:15], s29 offen offset:3072
    s_add_u32 s29, s29, 4096
    v_mfma_f32_16x16x32_bf16 v[92:95], a[152:155], v[44:47], v[92:95]
    ds_read_b128 v[60:63], v8 offset:30720
    v_mfma_f32_16x16x32_bf16 v[100:103], a[156:159], v[32:35], v[100:103]
    v_mfma_f32_16x16x32_bf16 v[108:111], a[156:159], v[36:39], v[108:111]
    v_mfma_f32_16x16x32_bf16 v[224:227], v[16:19], v[160:163], v[224:227]
    buffer_load_dwordx4 a[16:19], v5, s[12:15], s37 offen offset:0
    v_mfma_f32_16x16x32_bf16 v[116:119], a[156:159], v[40:43], v[116:119]
    v_mfma_f32_16x16x32_bf16 v[124:127], a[156:159], v[44:47], v[124:127]
    v_mfma_f32_16x16x32_bf16 v[132:135], a[160:163], v[32:35], v[132:135]
    v_mfma_f32_16x16x32_bf16 v[240:243], v[160:163], v[160:163], v[240:243]
    v_mfma_f32_16x16x32_bf16 v[140:143], a[160:163], v[36:39], v[140:143]
    buffer_load_dwordx4 a[20:23], v5, s[12:15], s37 offen offset:1024
    v_mfma_f32_16x16x32_bf16 v[148:151], a[160:163], v[40:43], v[148:151]
    v_mfma_f32_16x16x32_bf16 v[156:159], a[160:163], v[44:47], v[156:159]
    buffer_load_dwordx4 a[24:27], v5, s[12:15], s29 offen offset:0
    v_mfma_f32_16x16x32_bf16 v[228:231], v[16:19], v[168:171], v[228:231]
    s_waitcnt vmcnt(31)
    s_waitcnt lgkmcnt(0)
    v_mfma_f32_16x16x32_bf16 v[68:71], a[164:167], v[48:51], v[68:71]
    ds_read_b128 v[32:35], v7 offset:32768
    v_mfma_f32_16x16x32_bf16 v[76:79], a[164:167], v[52:55], v[76:79]
    ds_read_b128 v[36:39], v7 offset:34816
    v_mfma_f32_16x16x32_bf16 v[84:87], a[164:167], v[56:59], v[84:87]
    buffer_load_dwordx4 a[28:31], v5, s[12:15], s37 offen offset:2048
    ds_read_b128 v[40:43], v7 offset:36864
    v_mfma_f32_16x16x32_bf16 v[92:95], a[164:167], v[60:63], v[92:95]
    ds_read_b128 v[44:47], v7 offset:38912
    v_mfma_f32_16x16x32_bf16 v[100:103], a[168:171], v[48:51], v[100:103]
    v_mfma_f32_16x16x32_bf16 v[108:111], a[168:171], v[52:55], v[108:111]
    v_mfma_f32_16x16x32_bf16 v[244:247], v[168:171], v[168:171], v[244:247]
    buffer_load_dwordx4 a[32:35], v5, s[12:15], s37 offen offset:3072
    s_add_u32 s37, s37, 4096
    v_mfma_f32_16x16x32_bf16 v[116:119], a[168:171], v[56:59], v[116:119]
    v_mfma_f32_16x16x32_bf16 v[124:127], a[168:171], v[60:63], v[124:127]
    v_mfma_f32_16x16x32_bf16 v[132:135], a[172:175], v[48:51], v[132:135]
    v_mfma_f32_16x16x32_bf16 v[232:235], v[16:19], v[176:179], v[232:235]
    v_mfma_f32_16x16x32_bf16 v[140:143], a[172:175], v[52:55], v[140:143]
    buffer_load_dwordx4 a[36:39], v5, s[12:15], s29 offen offset:1024
    v_mfma_f32_16x16x32_bf16 v[148:151], a[172:175], v[56:59], v[148:151]
    v_mfma_f32_16x16x32_bf16 v[156:159], a[172:175], v[60:63], v[156:159]
    v_mfma_f32_16x16x32_bf16 v[248:251], v[176:179], v[176:179], v[248:251]
    s_waitcnt vmcnt(31)
    s_waitcnt lgkmcnt(0)
    v_mfma_f32_16x16x32_bf16 v[68:71], a[176:179], v[32:35], v[68:71]
    ds_read_b128 v[48:51], v8 offset:32768
    buffer_load_dwordx4 a[40:43], v5, s[12:15], s37 offen offset:0
    v_mfma_f32_16x16x32_bf16 v[76:79], a[176:179], v[36:39], v[76:79]
    ds_read_b128 v[52:55], v8 offset:34816
    v_mfma_f32_16x16x32_bf16 v[84:87], a[176:179], v[40:43], v[84:87]
    ds_read_b128 v[56:59], v8 offset:36864
    v_mfma_f32_16x16x32_bf16 v[92:95], a[176:179], v[44:47], v[92:95]
    ds_read_b128 v[60:63], v8 offset:38912
    v_mfma_f32_16x16x32_bf16 v[100:103], a[180:183], v[32:35], v[100:103]
    v_mfma_f32_16x16x32_bf16 v[108:111], a[180:183], v[36:39], v[108:111]
    buffer_load_dwordx4 a[44:47], v5, s[12:15], s37 offen offset:1024
    v_mfma_f32_16x16x32_bf16 v[236:239], v[16:19], v[184:187], v[236:239]
    v_mfma_f32_16x16x32_bf16 v[116:119], a[180:183], v[40:43], v[116:119]
    v_mfma_f32_16x16x32_bf16 v[124:127], a[180:183], v[44:47], v[124:127]
    v_mfma_f32_16x16x32_bf16 v[132:135], a[184:187], v[32:35], v[132:135]
    buffer_load_dwordx4 a[48:51], v5, s[12:15], s29 offen offset:2048
    v_mfma_f32_16x16x32_bf16 v[252:255], v[184:187], v[184:187], v[252:255]
    v_mfma_f32_16x16x32_bf16 v[140:143], a[184:187], v[36:39], v[140:143]
    v_mfma_f32_16x16x32_bf16 v[148:151], a[184:187], v[40:43], v[148:151]
    v_mfma_f32_16x16x32_bf16 v[156:159], a[184:187], v[44:47], v[156:159]
    v_mfma_f32_16x16x32_bf16 v[224:227], v[16:19], v[192:195], v[224:227]
    buffer_load_dwordx4 a[52:55], v5, s[12:15], s37 offen offset:2048
    s_waitcnt vmcnt(32)
    s_waitcnt lgkmcnt(0)
    v_mfma_f32_16x16x32_bf16 v[68:71], a[188:191], v[48:51], v[68:71]
    ds_read_b128 v[32:35], v24 offset:0
    v_mfma_f32_16x16x32_bf16 v[76:79], a[188:191], v[52:55], v[76:79]
    ds_read_b128 v[36:39], v24 offset:2048
    v_mfma_f32_16x16x32_bf16 v[84:87], a[188:191], v[56:59], v[84:87]
    ds_read_b128 v[40:43], v24 offset:4096
    buffer_load_dwordx4 a[56:59], v5, s[12:15], s37 offen offset:3072
    s_add_u32 s37, s37, 4096
    v_mfma_f32_16x16x32_bf16 v[92:95], a[188:191], v[60:63], v[92:95]
    ds_read_b128 v[44:47], v24 offset:6144
    v_mfma_f32_16x16x32_bf16 v[100:103], a[192:195], v[48:51], v[100:103]
    v_mfma_f32_16x16x32_bf16 v[108:111], a[192:195], v[52:55], v[108:111]
    v_mfma_f32_16x16x32_bf16 v[240:243], v[192:195], v[192:195], v[240:243]
    buffer_load_dwordx4 a[60:63], v5, s[12:15], s29 offen offset:3072
    s_add_u32 s29, s29, 4096
    v_mfma_f32_16x16x32_bf16 v[116:119], a[192:195], v[56:59], v[116:119]
    v_mfma_f32_16x16x32_bf16 v[124:127], a[192:195], v[60:63], v[124:127]
    v_mfma_f32_16x16x32_bf16 v[132:135], a[196:199], v[48:51], v[132:135]
    v_mfma_f32_16x16x32_bf16 v[228:231], v[16:19], v[200:203], v[228:231]
    v_mfma_f32_16x16x32_bf16 v[140:143], a[196:199], v[52:55], v[140:143]
    buffer_load_dwordx4 a[64:67], v5, s[12:15], s58 offen offset:0
    v_mfma_f32_16x16x32_bf16 v[148:151], a[196:199], v[56:59], v[148:151]
    v_mfma_f32_16x16x32_bf16 v[156:159], a[196:199], v[60:63], v[156:159]
    v_mfma_f32_16x16x32_bf16 v[244:247], v[200:203], v[200:203], v[244:247]
    s_waitcnt vmcnt(32)
    s_waitcnt lgkmcnt(0)
    v_mfma_f32_16x16x32_bf16 v[68:71], a[200:203], v[32:35], v[68:71]
    buffer_load_dwordx4 a[68:71], v5, s[12:15], s58 offen offset:1024
    ds_read_b128 v[48:51], v25 offset:0
    v_mfma_f32_16x16x32_bf16 v[76:79], a[200:203], v[36:39], v[76:79]
    ds_read_b128 v[52:55], v25 offset:2048
    v_mfma_f32_16x16x32_bf16 v[84:87], a[200:203], v[40:43], v[84:87]
    ds_read_b128 v[56:59], v25 offset:4096
    v_mfma_f32_16x16x32_bf16 v[92:95], a[200:203], v[44:47], v[92:95]
    ds_read_b128 v[60:63], v25 offset:6144
    v_mfma_f32_16x16x32_bf16 v[100:103], a[204:207], v[32:35], v[100:103]
    buffer_load_dwordx4 a[72:75], v5, s[12:15], s58 offen offset:2048
    v_mfma_f32_16x16x32_bf16 v[108:111], a[204:207], v[36:39], v[108:111]
    v_mfma_f32_16x16x32_bf16 v[232:235], v[16:19], v[208:211], v[232:235]
    v_mfma_f32_16x16x32_bf16 v[116:119], a[204:207], v[40:43], v[116:119]
    v_mfma_f32_16x16x32_bf16 v[124:127], a[204:207], v[44:47], v[124:127]
    v_mfma_f32_16x16x32_bf16 v[132:135], a[208:211], v[32:35], v[132:135]
    buffer_load_dwordx4 a[76:79], v5, s[12:15], s58 offen offset:3072
    s_add_u32 s58, s58, 4096
    v_mfma_f32_16x16x32_bf16 v[248:251], v[208:211], v[208:211], v[248:251]
    v_mfma_f32_16x16x32_bf16 v[140:143], a[208:211], v[36:39], v[140:143]
    v_mfma_f32_16x16x32_bf16 v[148:151], a[208:211], v[40:43], v[148:151]
    v_mfma_f32_16x16x32_bf16 v[156:159], a[208:211], v[44:47], v[156:159]
    buffer_load_dwordx4 a[80:83], v5, s[12:15], s58 offen offset:0
    v_mfma_f32_16x16x32_bf16 v[236:239], v[16:19], v[216:219], v[236:239]
    s_waitcnt vmcnt(33)
    s_waitcnt lgkmcnt(0)
    v_mfma_f32_16x16x32_bf16 v[68:71], a[212:215], v[48:51], v[68:71]
    ds_read_b128 v[32:35], v24 offset:8192
    v_mfma_f32_16x16x32_bf16 v[76:79], a[212:215], v[52:55], v[76:79]
    ds_read_b128 v[36:39], v24 offset:10240
    v_mfma_f32_16x16x32_bf16 v[84:87], a[212:215], v[56:59], v[84:87]
    buffer_load_dwordx4 a[84:87], v5, s[12:15], s58 offen offset:1024
    ds_read_b128 v[40:43], v24 offset:12288
    v_mfma_f32_16x16x32_bf16 v[92:95], a[212:215], v[60:63], v[92:95]
    ds_read_b128 v[44:47], v24 offset:14336
    v_mfma_f32_16x16x32_bf16 v[100:103], a[216:219], v[48:51], v[100:103]
    v_mfma_f32_16x16x32_bf16 v[108:111], a[216:219], v[52:55], v[108:111]
    v_mfma_f32_16x16x32_bf16 v[252:255], v[216:219], v[216:219], v[252:255]
    buffer_load_dwordx4 a[88:91], v5, s[12:15], s58 offen offset:2048
    v_mfma_f32_16x16x32_bf16 v[116:119], a[216:219], v[56:59], v[116:119]
    v_mfma_f32_16x16x32_bf16 v[124:127], a[216:219], v[60:63], v[124:127]
    v_mfma_f32_16x16x32_bf16 v[132:135], a[220:223], v[48:51], v[132:135]
    v_mfma_f32_16x16x32_bf16 v[140:143], a[220:223], v[52:55], v[140:143]
    v_mfma_f32_16x16x32_bf16 v[148:151], a[220:223], v[56:59], v[148:151]
    buffer_load_dwordx4 a[92:95], v5, s[12:15], s58 offen offset:3072
    s_add_u32 s58, s58, 4096
    v_mfma_f32_16x16x32_bf16 v[156:159], a[220:223], v[60:63], v[156:159]
    s_waitcnt vmcnt(33)
    s_waitcnt lgkmcnt(0)
    v_mfma_f32_16x16x32_bf16 v[68:71], a[224:227], v[32:35], v[68:71]
    ds_read_b128 v[48:51], v25 offset:8192
    v_mfma_f32_16x16x32_bf16 v[76:79], a[224:227], v[36:39], v[76:79]
    ds_read_b128 v[52:55], v25 offset:10240
    v_mfma_f32_16x16x32_bf16 v[84:87], a[224:227], v[40:43], v[84:87]
    buffer_load_dwordx4 a[96:99], v5, s[12:15], s58 offen offset:0
    ds_read_b128 v[56:59], v25 offset:12288
    v_mfma_f32_16x16x32_bf16 v[92:95], a[224:227], v[44:47], v[92:95]
    ds_read_b128 v[60:63], v25 offset:14336
    v_mfma_f32_16x16x32_bf16 v[100:103], a[228:231], v[32:35], v[100:103]
    v_mfma_f32_16x16x32_bf16 v[108:111], a[228:231], v[36:39], v[108:111]
    v_mfma_f32_16x16x32_bf16 v[116:119], a[228:231], v[40:43], v[116:119]
    buffer_load_dwordx4 a[100:103], v5, s[12:15], s58 offen offset:1024
    v_mfma_f32_16x16x32_bf16 v[124:127], a[228:231], v[44:47], v[124:127]
    v_mfma_f32_16x16x32_bf16 v[132:135], a[232:235], v[32:35], v[132:135]
    v_mfma_f32_16x16x32_bf16 v[140:143], a[232:235], v[36:39], v[140:143]
    v_mfma_f32_16x16x32_bf16 v[148:151], a[232:235], v[40:43], v[148:151]
    v_mfma_f32_16x16x32_bf16 v[156:159], a[232:235], v[44:47], v[156:159]
    buffer_load_dwordx4 a[104:107], v5, s[12:15], s58 offen offset:2048
    s_waitcnt vmcnt(33)
    s_waitcnt lgkmcnt(0)
    v_mfma_f32_16x16x32_bf16 v[68:71], a[236:239], v[48:51], v[68:71]
    ds_read_b128 v[32:35], v24 offset:16384
    v_and_b32 v22, 3, v3
    v_cmp_eq_u32 s[52:53], 1, v22
    v_mfma_f32_16x16x32_bf16 v[76:79], a[236:239], v[52:55], v[76:79]
    ds_read_b128 v[36:39], v24 offset:18432
    v_cmp_eq_u32 s[54:55], 2, v22
    buffer_load_dwordx4 a[108:111], v5, s[12:15], s58 offen offset:3072
    s_add_u32 s58, s58, 4096
    v_cmp_eq_u32 s[56:57], 3, v22
    v_mfma_f32_16x16x32_bf16 v[84:87], a[236:239], v[56:59], v[84:87]
    ds_read_b128 v[40:43], v24 offset:20480
    v_lshlrev_b32 v30, 3, v3
    s_lshl_b32 s40, s26, 9
    v_mfma_f32_16x16x32_bf16 v[92:95], a[236:239], v[60:63], v[92:95]
    ds_read_b128 v[44:47], v24 offset:22528
    s_add_u32 s40, s40, 81920
    v_add_u32 v30, s40, v30
    v_mfma_f32_16x16x32_bf16 v[100:103], a[240:243], v[48:51], v[100:103]
    buffer_load_dwordx4 a[112:115], v5, s[12:15], s58 offen offset:0
    v_cndmask_b32 v225, v240, v241, s[52:53]
    v_cndmask_b32 v225, v225, v242, s[54:55]
    v_mfma_f32_16x16x32_bf16 v[108:111], a[240:243], v[52:55], v[108:111]
    v_cndmask_b32 v225, v225, v243, s[56:57]
    v_cndmask_b32 v229, v244, v245, s[52:53]
    v_mfma_f32_16x16x32_bf16 v[116:119], a[240:243], v[56:59], v[116:119]
    v_cndmask_b32 v229, v229, v246, s[54:55]
    v_cndmask_b32 v229, v229, v247, s[56:57]
    v_mfma_f32_16x16x32_bf16 v[124:127], a[240:243], v[60:63], v[124:127]
    v_cndmask_b32 v233, v248, v249, s[52:53]
    buffer_load_dwordx4 a[116:119], v5, s[12:15], s58 offen offset:1024
    v_cndmask_b32 v233, v233, v250, s[54:55]
    v_mfma_f32_16x16x32_bf16 v[132:135], a[244:247], v[48:51], v[132:135]
    v_cndmask_b32 v233, v233, v251, s[56:57]
    v_cndmask_b32 v237, v252, v253, s[52:53]
    v_mfma_f32_16x16x32_bf16 v[140:143], a[244:247], v[52:55], v[140:143]
    v_cndmask_b32 v237, v237, v254, s[54:55]
    v_cndmask_b32 v237, v237, v255, s[56:57]
    v_mfma_f32_16x16x32_bf16 v[148:151], a[244:247], v[56:59], v[148:151]
    v_lshlrev_b32 v29, 3, v2
    v_add_u32 v29, 81920, v29
    v_mfma_f32_16x16x32_bf16 v[156:159], a[244:247], v[60:63], v[156:159]
    buffer_load_dwordx4 a[120:123], v5, s[12:15], s58 offen offset:2048
    s_mov_b32 exec_lo, 0x00f0000f
    s_mov_b32 exec_hi, 0xf0000f00
    ds_write_b64 v30, v[224:225] offset:0
    ds_write_b64 v30, v[228:229] offset:128
    ds_write_b64 v30, v[232:233] offset:256
    ds_write_b64 v30, v[236:237] offset:384
    s_mov_b64 exec, -1
    s_waitcnt vmcnt(34)
    s_waitcnt lgkmcnt(4)
    v_mfma_f32_16x16x32_bf16 v[68:71], a[248:251], v[32:35], v[68:71]
    buffer_load_dwordx4 a[124:127], v5, s[12:15], s58 offen offset:3072
    s_add_u32 s58, s58, 4096
    ds_read_b128 v[48:51], v25 offset:16384
    v_mfma_f32_16x16x32_bf16 v[76:79], a[248:251], v[36:39], v[76:79]
    ds_read_b128 v[52:55], v25 offset:18432
    v_mfma_f32_16x16x32_bf16 v[84:87], a[248:251], v[40:43], v[84:87]
    ds_read_b128 v[56:59], v25 offset:20480
    v_mfma_f32_16x16x32_bf16 v[92:95], a[248:251], v[44:47], v[92:95]
    ds_read_b128 v[60:63], v25 offset:22528
    v_mfma_f32_16x16x32_bf16 v[100:103], a[252:255], v[32:35], v[100:103]
    buffer_load_dwordx4 a[128:131], v5, s[12:15], s58 offen offset:0
    v_mfma_f32_16x16x32_bf16 v[108:111], a[252:255], v[36:39], v[108:111]
    v_mfma_f32_16x16x32_bf16 v[116:119], a[252:255], v[40:43], v[116:119]
    v_mfma_f32_16x16x32_bf16 v[124:127], a[252:255], v[44:47], v[124:127]
    v_mfma_f32_16x16x32_bf16 v[132:135], a[0:3], v[32:35], v[132:135]
    v_mfma_f32_16x16x32_bf16 v[140:143], a[0:3], v[36:39], v[140:143]
    buffer_load_dwordx4 a[132:135], v5, s[12:15], s58 offen offset:1024
    v_mfma_f32_16x16x32_bf16 v[148:151], a[0:3], v[40:43], v[148:151]
    v_mfma_f32_16x16x32_bf16 v[156:159], a[0:3], v[44:47], v[156:159]
    s_waitcnt lgkmcnt(4)
    s_barrier
    ds_read_b64 v[224:225], v29 offset:0
    ds_read_b64 v[226:227], v29 offset:512
    ds_read_b64 v[228:229], v29 offset:1024
    buffer_load_dwordx4 a[136:139], v5, s[12:15], s58 offen offset:2048
    ds_read_b64 v[230:231], v29 offset:1536
    s_waitcnt vmcnt(31)
    s_waitcnt lgkmcnt(4)
    v_mfma_f32_16x16x32_bf16 v[68:71], a[4:7], v[48:51], v[68:71]
    ds_read_b128 v[32:35], v24 offset:24576
    v_mfma_f32_16x16x32_bf16 v[76:79], a[4:7], v[52:55], v[76:79]
    ds_read_b128 v[36:39], v24 offset:26624
    v_mfma_f32_16x16x32_bf16 v[84:87], a[4:7], v[56:59], v[84:87]
    ds_read_b128 v[40:43], v24 offset:28672
    buffer_load_dwordx4 a[140:143], v5, s[12:15], s58 offen offset:3072
    s_add_u32 s58, s58, 4096
    v_mfma_f32_16x16x32_bf16 v[92:95], a[4:7], v[60:63], v[92:95]
    ds_read_b128 v[44:47], v24 offset:30720
    v_mfma_f32_16x16x32_bf16 v[100:103], a[8:11], v[48:51], v[100:103]
    v_mfma_f32_16x16x32_bf16 v[108:111], a[8:11], v[52:55], v[108:111]
    v_mfma_f32_16x16x32_bf16 v[116:119], a[8:11], v[56:59], v[116:119]
    v_mfma_f32_16x16x32_bf16 v[124:127], a[8:11], v[60:63], v[124:127]
    buffer_load_dwordx4 a[144:147], v5, s[12:15], s58 offen offset:0
    v_mfma_f32_16x16x32_bf16 v[132:135], a[12:15], v[48:51], v[132:135]
    v_mfma_f32_16x16x32_bf16 v[140:143], a[12:15], v[52:55], v[140:143]
    v_mfma_f32_16x16x32_bf16 v[148:151], a[12:15], v[56:59], v[148:151]
    v_mfma_f32_16x16x32_bf16 v[156:159], a[12:15], v[60:63], v[156:159]
    buffer_load_dwordx4 a[148:151], v5, s[12:15], s58 offen offset:1024
    s_waitcnt lgkmcnt(4)
    s_waitcnt vmcnt(31)
    s_waitcnt lgkmcnt(0)
    v_mfma_f32_16x16x32_bf16 v[68:71], a[16:19], v[32:35], v[68:71]
    ds_read_b128 v[48:51], v25 offset:24576
    v_add_f32 v224, v224, v226
    v_add_f32 v225, v225, v227
    v_mfma_f32_16x16x32_bf16 v[76:79], a[16:19], v[36:39], v[76:79]
    ds_read_b128 v[52:55], v25 offset:26624
    v_add_f32 v228, v228, v230
    v_add_f32 v229, v229, v231
    buffer_load_dwordx4 a[152:155], v5, s[12:15], s58 offen offset:2048
    v_mfma_f32_16x16x32_bf16 v[84:87], a[16:19], v[40:43], v[84:87]
    ds_read_b128 v[56:59], v25 offset:28672
    v_add_f32 v224, v224, v228
    v_add_f32 v225, v225, v229
    v_mfma_f32_16x16x32_bf16 v[92:95], a[16:19], v[44:47], v[92:95]
    ds_read_b128 v[60:63], v25 offset:30720
    v_mul_f32 v224, 0x3acccccd, v224
    v_mul_f32 v225, 0x3acccccd, v225
    v_mfma_f32_16x16x32_bf16 v[100:103], a[20:23], v[32:35], v[100:103]
    buffer_load_dwordx4 a[156:159], v5, s[12:15], s58 offen offset:3072
    s_add_u32 s58, s58, 4096
    v_fma_f32 v225, -v224, v224, v225
    v_max_f32 v225, 0, v225
    v_mfma_f32_16x16x32_bf16 v[108:111], a[20:23], v[36:39], v[108:111]
    v_add_f32 v225, 0x3727c5ac, v225
    v_rsq_f32 v225, v225
    v_mfma_f32_16x16x32_bf16 v[116:119], a[20:23], v[40:43], v[116:119]
    v_lshlrev_b32 v31, 3, v2
    v_add_u32 v31, s40, v31
    v_mfma_f32_16x16x32_bf16 v[124:127], a[20:23], v[44:47], v[124:127]
    v_mul_f32 v224, v224, v225
    buffer_load_dwordx4 a[160:163], v5, s[12:15], s58 offen offset:0
    v_mfma_f32_16x16x32_bf16 v[132:135], a[24:27], v[32:35], v[132:135]
    v_mfma_f32_16x16x32_bf16 v[140:143], a[24:27], v[36:39], v[140:143]
    v_mfma_f32_16x16x32_bf16 v[148:151], a[24:27], v[40:43], v[148:151]
    v_mfma_f32_16x16x32_bf16 v[156:159], a[24:27], v[44:47], v[156:159]
    ds_write_b64 v31, v[224:225] offset:2048
    buffer_load_dwordx4 a[164:167], v5, s[12:15], s58 offen offset:1024
    ds_read_b64 v[232:233], v30 offset:2048
    ds_read_b64 v[234:235], v30 offset:2176
    ds_read_b64 v[236:237], v30 offset:2304
    ds_read_b64 v[238:239], v30 offset:2432
    v_add_f32 v212, v212, v213
    v_lshlrev_b32 v214, 16, v214
    ds_write_b32 v15, v212
    ds_write_b32 v15, v214 offset:256
    buffer_load_dwordx4 a[168:171], v5, s[12:15], s58 offen offset:2048
    ds_write_b32 v15, v215 offset:512
    ds_read_b128 v[164:167], v21 offset:0
    ds_read_b128 v[172:175], v21 offset:64
    ds_read_b128 v[180:183], v21 offset:128
    ds_read_b128 v[188:191], v21 offset:256
    ds_read_b128 v[196:199], v21 offset:320
    ds_read_b128 v[204:207], v21 offset:384
    s_waitcnt vmcnt(33)
    s_waitcnt lgkmcnt(14)
    v_mfma_f32_16x16x32_bf16 v[68:71], a[28:31], v[48:51], v[68:71]
    buffer_load_dwordx4 a[172:175], v5, s[12:15], s58 offen offset:3072
    s_add_u32 s58, s58, 4096
    ds_read_b128 v[32:35], v24 offset:32768
    v_mfma_f32_16x16x32_bf16 v[76:79], a[28:31], v[52:55], v[76:79]
    ds_read_b128 v[36:39], v24 offset:34816
    v_mfma_f32_16x16x32_bf16 v[84:87], a[28:31], v[56:59], v[84:87]
    ds_read_b128 v[40:43], v24 offset:36864
    v_mfma_f32_16x16x32_bf16 v[92:95], a[28:31], v[60:63], v[92:95]
    ds_read_b128 v[44:47], v24 offset:38912
    buffer_load_dwordx4 a[176:179], v5, s[12:15], s58 offen offset:0
    v_mfma_f32_16x16x32_bf16 v[100:103], a[32:35], v[48:51], v[100:103]
    v_mfma_f32_16x16x32_bf16 v[108:111], a[32:35], v[52:55], v[108:111]
    v_mfma_f32_16x16x32_bf16 v[116:119], a[32:35], v[56:59], v[116:119]
    v_mfma_f32_16x16x32_bf16 v[124:127], a[32:35], v[60:63], v[124:127]
    v_mfma_f32_16x16x32_bf16 v[132:135], a[36:39], v[48:51], v[132:135]
    buffer_load_dwordx4 a[180:183], v5, s[12:15], s58 offen offset:1024
    v_mfma_f32_16x16x32_bf16 v[140:143], a[36:39], v[52:55], v[140:143]
    v_mfma_f32_16x16x32_bf16 v[148:151], a[36:39], v[56:59], v[148:151]
    v_mfma_f32_16x16x32_bf16 v[156:159], a[36:39], v[60:63], v[156:159]
    s_waitcnt lgkmcnt(4)
    s_waitcnt vmcnt(33)
    s_waitcnt lgkmcnt(0)
    v_mfma_f32_16x16x32_bf16 v[68:71], a[40:43], v[32:35], v[68:71]
    buffer_load_dwordx4 a[184:187], v5, s[12:15], s58 offen offset:2048
    ds_read_b128 v[48:51], v25 offset:32768
    v_fma_f32 v64, -v232, v164, v188
    v_fma_f32 v65, -v232, v165, v189
    v_mfma_f32_16x16x32_bf16 v[76:79], a[40:43], v[36:39], v[76:79]
    ds_read_b128 v[52:55], v25 offset:34816
    v_fma_f32 v66, -v232, v166, v190
    v_fma_f32 v67, -v232, v167, v191
    v_mfma_f32_16x16x32_bf16 v[84:87], a[40:43], v[40:43], v[84:87]
    ds_read_b128 v[56:59], v25 offset:36864
    buffer_load_dwordx4 a[188:191], v5, s[12:15], s58 offen offset:3072
    s_add_u32 s58, s58, 4096
    v_fma_f32 v96, -v232, v172, v196
    v_fma_f32 v97, -v232, v173, v197
    v_mfma_f32_16x16x32_bf16 v[92:95], a[40:43], v[44:47], v[92:95]
    ds_read_b128 v[60:63], v25 offset:38912
    v_fma_f32 v98, -v232, v174, v198
    v_fma_f32 v99, -v232, v175, v199
    v_mfma_f32_16x16x32_bf16 v[100:103], a[44:47], v[32:35], v[100:103]
    v_fma_f32 v128, -v232, v180, v204
    v_fma_f32 v129, -v232, v181, v205
    v_mfma_f32_16x16x32_bf16 v[108:111], a[44:47], v[36:39], v[108:111]
    buffer_load_dwordx4 a[192:195], v5, s[12:15], s58 offen offset:0
    v_fma_f32 v130, -v232, v182, v206
    v_fma_f32 v131, -v232, v183, v207
    v_mfma_f32_16x16x32_bf16 v[116:119], a[44:47], v[40:43], v[116:119]
    v_fma_f32 v72, -v234, v164, v188
    v_fma_f32 v73, -v234, v165, v189
    v_mfma_f32_16x16x32_bf16 v[124:127], a[44:47], v[44:47], v[124:127]
    v_fma_f32 v74, -v234, v166, v190
    v_fma_f32 v75, -v234, v167, v191
    v_mfma_f32_16x16x32_bf16 v[132:135], a[48:51], v[32:35], v[132:135]
    v_fma_f32 v104, -v234, v172, v196
    buffer_load_dwordx4 a[196:199], v5, s[12:15], s58 offen offset:1024
    v_fma_f32 v105, -v234, v173, v197
    v_mfma_f32_16x16x32_bf16 v[140:143], a[48:51], v[36:39], v[140:143]
    v_fma_f32 v106, -v234, v174, v198
    v_fma_f32 v107, -v234, v175, v199
    v_mfma_f32_16x16x32_bf16 v[148:151], a[48:51], v[40:43], v[148:151]
    v_fma_f32 v136, -v234, v180, v204
    v_fma_f32 v137, -v234, v181, v205
    v_mfma_f32_16x16x32_bf16 v[156:159], a[48:51], v[44:47], v[156:159]
    v_fma_f32 v138, -v234, v182, v206
    v_fma_f32 v139, -v234, v183, v207
    s_waitcnt vmcnt(34)
    s_waitcnt lgkmcnt(0)
    v_mfma_f32_16x16x32_bf16 v[68:71], a[52:55], v[48:51], v[68:71]
    buffer_load_dwordx4 a[200:203], v5, s[12:15], s58 offen offset:2048
    v_fma_f32 v80, -v236, v164, v188
    v_fma_f32 v81, -v236, v165, v189
    v_mfma_f32_16x16x32_bf16 v[76:79], a[52:55], v[52:55], v[76:79]
    v_fma_f32 v82, -v236, v166, v190
    v_fma_f32 v83, -v236, v167, v191
    v_mfma_f32_16x16x32_bf16 v[84:87], a[52:55], v[56:59], v[84:87]
    v_fma_f32 v112, -v236, v172, v196
    v_fma_f32 v113, -v236, v173, v197
    v_mfma_f32_16x16x32_bf16 v[92:95], a[52:55], v[60:63], v[92:95]
    buffer_load_dwordx4 a[204:207], v5, s[12:15], s58 offen offset:3072
    s_add_u32 s58, s58, 4096
    v_fma_f32 v114, -v236, v174, v198
    v_fma_f32 v115, -v236, v175, v199
    v_mfma_f32_16x16x32_bf16 v[100:103], a[56:59], v[48:51], v[100:103]
    v_fma_f32 v144, -v236, v180, v204
    v_fma_f32 v145, -v236, v181, v205
    v_mfma_f32_16x16x32_bf16 v[108:111], a[56:59], v[52:55], v[108:111]
    v_fma_f32 v146, -v236, v182, v206
    v_fma_f32 v147, -v236, v183, v207
    v_mfma_f32_16x16x32_bf16 v[116:119], a[56:59], v[56:59], v[116:119]
    v_fma_f32 v88, -v238, v164, v188
    buffer_load_dwordx4 a[208:211], v5, s[12:15], s58 offen offset:0
    v_fma_f32 v89, -v238, v165, v189
    v_mfma_f32_16x16x32_bf16 v[124:127], a[56:59], v[60:63], v[124:127]
    v_fma_f32 v90, -v238, v166, v190
    v_fma_f32 v91, -v238, v167, v191
    v_mfma_f32_16x16x32_bf16 v[132:135], a[60:63], v[48:51], v[132:135]
    v_fma_f32 v120, -v238, v172, v196
    v_fma_f32 v121, -v238, v173, v197
    v_mfma_f32_16x16x32_bf16 v[140:143], a[60:63], v[52:55], v[140:143]
    v_fma_f32 v122, -v238, v174, v198
    v_fma_f32 v123, -v238, v175, v199
    v_mfma_f32_16x16x32_bf16 v[148:151], a[60:63], v[56:59], v[148:151]
    buffer_load_dwordx4 a[212:215], v5, s[12:15], s58 offen offset:1024
    v_fma_f32 v152, -v238, v180, v204
    v_fma_f32 v153, -v238, v181, v205
    v_mfma_f32_16x16x32_bf16 v[156:159], a[60:63], v[60:63], v[156:159]
    v_fma_f32 v154, -v238, v182, v206
    v_fma_f32 v155, -v238, v183, v207
    s_mul_i32 s41, s22, 48
    s_mul_i32 s42, s23, 6
    s_add_u32 s51, s41, s42
    s_add_u32 s42, s51, s26
    s_lshl_b32 s42, s42, 12
    s_add_u32 s42, s42, 7901184
    s_lshr_b32 s43, s26, 1
    s_lshl_b32 s49, s43, 12
    buffer_load_dwordx4 a[216:219], v5, s[12:15], s58 offen offset:2048
    s_add_u32 s49, s49, 86016
    s_add_u32 s43, s43, s51
    s_add_u32 s43, s43, 4
    s_lshl_b32 s43, s43, 12
    s_and_b32 s44, s26, 1
    s_lshl_b32 s50, s44, 3
    s_add_u32 s50, s50, s49
    s_lshl_b32 s44, s44, 11
    s_add_u32 s43, s43, s44
    s_add_u32 s43, s43, 7901184
    s_add_u32 s49, s49, s44
    v_add_u32 v10, s50, v5
    v_add_u32 v11, s49, v5
    v_pk_fma_f32 v[68:69], v[68:69], v[232:233], v[64:65] op_sel:[0,1,0] op_sel_hi:[1,1,1]
    v_pk_fma_f32 v[70:71], v[70:71], v[232:233], v[66:67] op_sel:[0,1,0] op_sel_hi:[1,1,1]
    buffer_load_dwordx4 a[220:223], v5, s[12:15], s58 offen offset:3072
    s_add_u32 s58, s58, 4096
    v_max_f32 v68, 0, v68
    v_max_f32 v69, 0, v69
    v_max_f32 v70, 0, v70
    v_max_f32 v71, 0, v71
    v_pk_mul_f32 v[68:69], v[68:69], v[68:69]
    v_pk_mul_f32 v[70:71], v[70:71], v[70:71]
    v_cvt_pk_bf16_f32 v160, v68, v69
    v_cvt_pk_bf16_f32 v161, v70, v71
    v_pk_fma_f32 v[100:101], v[100:101], v[232:233], v[96:97] op_sel:[0,1,0] op_sel_hi:[1,1,1]
    buffer_load_dwordx4 a[224:227], v5, s[12:15], s58 offen offset:0
    v_pk_fma_f32 v[102:103], v[102:103], v[232:233], v[98:99] op_sel:[0,1,0] op_sel_hi:[1,1,1]
    v_max_f32 v100, 0, v100
    v_max_f32 v101, 0, v101
    v_max_f32 v102, 0, v102
    v_max_f32 v103, 0, v103
    v_pk_mul_f32 v[100:101], v[100:101], v[100:101]
    v_pk_mul_f32 v[102:103], v[102:103], v[102:103]
    v_cvt_pk_bf16_f32 v162, v100, v101
    v_cvt_pk_bf16_f32 v163, v102, v103
    buffer_store_dwordx4 v[160:163], v5, s[12:15], s42 offen sc1
    v_pk_fma_f32 v[132:133], v[132:133], v[232:233], v[128:129] op_sel:[0,1,0] op_sel_hi:[1,1,1]
    v_pk_fma_f32 v[134:135], v[134:135], v[232:233], v[130:131] op_sel:[0,1,0] op_sel_hi:[1,1,1]
    v_max_f32 v132, 0, v132
    v_max_f32 v133, 0, v133
    v_max_f32 v134, 0, v134
    v_max_f32 v135, 0, v135
    v_pk_mul_f32 v[132:133], v[132:133], v[132:133]
    v_pk_mul_f32 v[134:135], v[134:135], v[134:135]
    v_cvt_pk_bf16_f32 v192, v132, v133
    v_cvt_pk_bf16_f32 v193, v134, v135
    ds_write_b64 v10, v[192:193] offset:0
    v_pk_fma_f32 v[140:141], v[140:141], v[234:235], v[136:137] op_sel:[0,1,0] op_sel_hi:[1,1,1]
    buffer_load_dwordx4 a[228:231], v5, s[12:15], s58 offen offset:1024
    v_pk_fma_f32 v[142:143], v[142:143], v[234:235], v[138:139] op_sel:[0,1,0] op_sel_hi:[1,1,1]
    v_max_f32 v140, 0, v140
    v_max_f32 v141, 0, v141
    v_max_f32 v142, 0, v142
    v_max_f32 v143, 0, v143
    v_pk_mul_f32 v[140:141], v[140:141], v[140:141]
    v_pk_mul_f32 v[142:143], v[142:143], v[142:143]
    v_cvt_pk_bf16_f32 v200, v140, v141
    v_cvt_pk_bf16_f32 v201, v142, v143
    ds_write_b64 v10, v[200:201] offset:1024
    buffer_load_dwordx4 a[232:235], v5, s[12:15], s58 offen offset:2048
    v_pk_fma_f32 v[148:149], v[148:149], v[236:237], v[144:145] op_sel:[0,1,0] op_sel_hi:[1,1,1]
    v_pk_fma_f32 v[150:151], v[150:151], v[236:237], v[146:147] op_sel:[0,1,0] op_sel_hi:[1,1,1]
    v_max_f32 v148, 0, v148
    v_max_f32 v149, 0, v149
    v_max_f32 v150, 0, v150
    v_max_f32 v151, 0, v151
    v_pk_mul_f32 v[148:149], v[148:149], v[148:149]
    v_pk_mul_f32 v[150:151], v[150:151], v[150:151]
    v_cvt_pk_bf16_f32 v208, v148, v149
    v_cvt_pk_bf16_f32 v209, v150, v151
    buffer_load_dwordx4 a[236:239], v5, s[12:15], s58 offen offset:3072
    s_add_u32 s58, s58, 4096
    ds_write_b64 v10, v[208:209] offset:2048
    v_pk_fma_f32 v[156:157], v[156:157], v[238:239], v[152:153] op_sel:[0,1,0] op_sel_hi:[1,1,1]
    v_pk_fma_f32 v[158:159], v[158:159], v[238:239], v[154:155] op_sel:[0,1,0] op_sel_hi:[1,1,1]
    v_max_f32 v156, 0, v156
    v_max_f32 v157, 0, v157
    v_max_f32 v158, 0, v158
    v_max_f32 v159, 0, v159
    v_pk_mul_f32 v[156:157], v[156:157], v[156:157]
    v_pk_mul_f32 v[158:159], v[158:159], v[158:159]
    buffer_load_dwordx4 a[240:243], v5, s[12:15], s58 offen offset:0
    v_cvt_pk_bf16_f32 v216, v156, v157
    v_cvt_pk_bf16_f32 v217, v158, v159
    ds_write_b64 v10, v[216:217] offset:3072
    v_pk_fma_f32 v[76:77], v[76:77], v[234:235], v[72:73] op_sel:[0,1,0] op_sel_hi:[1,1,1]
    v_pk_fma_f32 v[78:79], v[78:79], v[234:235], v[74:75] op_sel:[0,1,0] op_sel_hi:[1,1,1]
    v_max_f32 v76, 0, v76
    v_max_f32 v77, 0, v77
    v_max_f32 v78, 0, v78
    v_max_f32 v79, 0, v79
    v_pk_mul_f32 v[76:77], v[76:77], v[76:77]
    buffer_load_dwordx4 a[244:247], v5, s[12:15], s58 offen offset:1024
    v_pk_mul_f32 v[78:79], v[78:79], v[78:79]
    v_cvt_pk_bf16_f32 v168, v76, v77
    v_cvt_pk_bf16_f32 v169, v78, v79
    v_pk_fma_f32 v[108:109], v[108:109], v[234:235], v[104:105] op_sel:[0,1,0] op_sel_hi:[1,1,1]
    v_pk_fma_f32 v[110:111], v[110:111], v[234:235], v[106:107] op_sel:[0,1,0] op_sel_hi:[1,1,1]
    v_max_f32 v108, 0, v108
    v_max_f32 v109, 0, v109
    v_max_f32 v110, 0, v110
    v_max_f32 v111, 0, v111
    v_pk_mul_f32 v[108:109], v[108:109], v[108:109]
    v_pk_mul_f32 v[110:111], v[110:111], v[110:111]
    buffer_load_dwordx4 a[248:251], v5, s[12:15], s58 offen offset:2048
    v_cvt_pk_bf16_f32 v170, v108, v109
    v_cvt_pk_bf16_f32 v171, v110, v111
    buffer_store_dwordx4 v[168:171], v5, s[12:15], s42 offen offset:1024 sc1
    v_pk_fma_f32 v[84:85], v[84:85], v[236:237], v[80:81] op_sel:[0,1,0] op_sel_hi:[1,1,1]
    v_pk_fma_f32 v[86:87], v[86:87], v[236:237], v[82:83] op_sel:[0,1,0] op_sel_hi:[1,1,1]
    v_max_f32 v84, 0, v84
    v_max_f32 v85, 0, v85
    v_max_f32 v86, 0, v86
    v_max_f32 v87, 0, v87
    v_pk_mul_f32 v[84:85], v[84:85], v[84:85]
    v_pk_mul_f32 v[86:87], v[86:87], v[86:87]
    v_cvt_pk_bf16_f32 v176, v84, v85
    v_cvt_pk_bf16_f32 v177, v86, v87
    v_pk_fma_f32 v[116:117], v[116:117], v[236:237], v[112:113] op_sel:[0,1,0] op_sel_hi:[1,1,1]
    v_pk_fma_f32 v[118:119], v[118:119], v[236:237], v[114:115] op_sel:[0,1,0] op_sel_hi:[1,1,1]
    buffer_load_dwordx4 a[252:255], v5, s[12:15], s58 offen offset:3072
    s_add_u32 s58, s58, 4096
    v_max_f32 v116, 0, v116
    v_max_f32 v117, 0, v117
    v_max_f32 v118, 0, v118
    v_max_f32 v119, 0, v119
    v_pk_mul_f32 v[116:117], v[116:117], v[116:117]
    v_pk_mul_f32 v[118:119], v[118:119], v[118:119]
    v_cvt_pk_bf16_f32 v178, v116, v117
    v_cvt_pk_bf16_f32 v179, v118, v119
    buffer_store_dwordx4 v[176:179], v5, s[12:15], s42 offen offset:2048 sc1
    s_waitcnt lgkmcnt(0)
    s_barrier
    ds_read_b128 v[192:195], v11 offset:0
    ds_read_b128 v[200:203], v11 offset:1024
    v_pk_fma_f32 v[92:93], v[92:93], v[238:239], v[88:89] op_sel:[0,1,0] op_sel_hi:[1,1,1]
    v_pk_fma_f32 v[94:95], v[94:95], v[238:239], v[90:91] op_sel:[0,1,0] op_sel_hi:[1,1,1]
    v_max_f32 v92, 0, v92
    v_max_f32 v93, 0, v93
    v_max_f32 v94, 0, v94
    v_max_f32 v95, 0, v95
    v_pk_mul_f32 v[92:93], v[92:93], v[92:93]
    v_pk_mul_f32 v[94:95], v[94:95], v[94:95]
    buffer_load_dwordx4 a[0:3], v5, s[12:15], s58 offen offset:0
    v_cvt_pk_bf16_f32 v184, v92, v93
    v_cvt_pk_bf16_f32 v185, v94, v95
    v_pk_fma_f32 v[124:125], v[124:125], v[238:239], v[120:121] op_sel:[0,1,0] op_sel_hi:[1,1,1]
    v_pk_fma_f32 v[126:127], v[126:127], v[238:239], v[122:123] op_sel:[0,1,0] op_sel_hi:[1,1,1]
    v_max_f32 v124, 0, v124
    v_max_f32 v125, 0, v125
    v_max_f32 v126, 0, v126
    v_max_f32 v127, 0, v127
    v_pk_mul_f32 v[124:125], v[124:125], v[124:125]
    v_pk_mul_f32 v[126:127], v[126:127], v[126:127]
    v_cvt_pk_bf16_f32 v186, v124, v125
    buffer_load_dwordx4 a[4:7], v5, s[12:15], s58 offen offset:1024
    v_cvt_pk_bf16_f32 v187, v126, v127
    buffer_store_dwordx4 v[184:187], v5, s[12:15], s42 offen offset:3072 sc1
    s_waitcnt lgkmcnt(0)
    buffer_store_dwordx4 v[192:195], v5, s[12:15], s43 offen offset:0 sc1
    buffer_store_dwordx4 v[200:203], v5, s[12:15], s43 offen offset:1024 sc1
    s_mul_i32 s45, s23, 160
    ds_read_b64 v[112:113], v6 offset:512
    ds_read_b64 v[114:115], v6 offset:544
    ds_read_b64 v[116:117], v6 offset:576
    ds_read_b64 v[118:119], v6 offset:608
    ds_read_b64 v[120:121], v6 offset:640
    s_lshl_b32 s46, s22, 8
    s_add_u32 s46, s46, 5263360
    s_lshl_b32 s59, s26, 6
    s_add_u32 s59, s59, s46
    s_lshr_b32 s47, s23, 1
    s_lshl_b32 s47, s47, 6
    s_add_u32 s46, s46, s47
    s_and_b32 s47, s23, 1
    s_lshl_b32 s47, s47, 2
    s_add_u32 s46, s46, s47
    v_mov_b32 v9, 0
    v_mov_b32 v28, 1
    s_mul_i32 s47, s23, 5
    s_add_u32 s48, s47, 0
    s_lshr_b32 s49, s48, 2
    s_lshl_b32 s49, s49, 13
    s_add_u32 s49, s49, s27
    s_and_b32 s50, s48, 1
    s_lshl_b32 s50, s50, 3
    s_add_u32 s49, s49, s50
    s_and_b32 s50, s48, 2
    s_lshl_b32 s50, s50, 5
    v_xor_b32 v29, s50, v7
    v_add_u32 v29, s49, v29
    ds_read_b64 v[122:123], v29
    s_add_u32 s48, s47, 1
    s_lshr_b32 s49, s48, 2
    s_lshl_b32 s49, s49, 13
    s_add_u32 s49, s49, s27
    s_and_b32 s50, s48, 1
    s_lshl_b32 s50, s50, 3
    s_add_u32 s49, s49, s50
    s_and_b32 s50, s48, 2
    s_lshl_b32 s50, s50, 5
    v_xor_b32 v29, s50, v7
    v_add_u32 v29, s49, v29
    ds_read_b64 v[124:125], v29
    s_add_u32 s48, s47, 2
    s_lshr_b32 s49, s48, 2
    s_lshl_b32 s49, s49, 13
    s_add_u32 s49, s49, s27
    s_and_b32 s50, s48, 1
    s_lshl_b32 s50, s50, 3
    s_add_u32 s49, s49, s50
    s_and_b32 s50, s48, 2
    s_lshl_b32 s50, s50, 5
    v_xor_b32 v29, s50, v7
    v_add_u32 v29, s49, v29
    ds_read_b64 v[126:127], v29
    s_add_u32 s48, s47, 3
    s_lshr_b32 s49, s48, 2
    s_lshl_b32 s49, s49, 13
    s_add_u32 s49, s49, s27
    s_and_b32 s50, s48, 1
    s_lshl_b32 s50, s50, 3
    s_add_u32 s49, s49, s50
    s_and_b32 s50, s48, 2
    s_lshl_b32 s50, s50, 5
    v_xor_b32 v29, s50, v7
    v_add_u32 v29, s49, v29
    ds_read_b64 v[128:129], v29
    s_add_u32 s48, s47, 4
    s_lshr_b32 s49, s48, 2
    s_lshl_b32 s49, s49, 13
    s_add_u32 s49, s49, s27
    s_and_b32 s50, s48, 1
    s_lshl_b32 s50, s50, 3
    s_add_u32 s49, s49, s50
    s_and_b32 s50, s48, 2
    s_lshl_b32 s50, s50, 5
    v_xor_b32 v29, s50, v7
    v_add_u32 v29, s49, v29
    ds_read_b64 v[130:131], v29
    v_add_u32 v10, 0, v1
    v_and_b32 v10, 3, v10
    v_mul_u32_u24 v14, 15360, v10
    v_lshl_add_u32 v10, v10, 10, v5
    v_add_u32 v14, v14, v5
    v_add_u32 v14, 86016, v14
    v_add_u32 v11, 1, v1
    v_and_b32 v11, 3, v11
    v_mul_u32_u24 v15, 15360, v11
    v_lshl_add_u32 v11, v11, 10, v5
    v_add_u32 v15, v15, v5
    v_add_u32 v15, 86016, v15
    v_add_u32 v12, 2, v1
    v_and_b32 v12, 3, v12
    v_mul_u32_u24 v16, 15360, v12
    v_lshl_add_u32 v12, v12, 10, v5
    v_add_u32 v16, v16, v5
    v_add_u32 v16, 86016, v16
    v_add_u32 v13, 3, v1
    v_and_b32 v13, 3, v13
    v_mul_u32_u24 v17, 15360, v13
    v_lshl_add_u32 v13, v13, 10, v5
    v_add_u32 v17, v17, v5
    v_add_u32 v17, 86016, v17
    s_mul_i32 s48, s26, 12
    s_add_u32 s48, s48, s41
    s_lshl_b32 s48, s48, 12
    s_add_u32 s48, s48, 7901184
    s_waitcnt vmcnt(0)
    s_barrier
    s_cmp_lg_u32 s26, 0
    s_cbranch_scc1 fnet_cd_kernel_nosig
    s_mov_b64 exec, 1
    buffer_store_dword v28, v9, s[12:15], s46 offen sc1
    s_mov_b64 exec, -1
fnet_cd_kernel_nosig:
    s_waitcnt lgkmcnt(0)
    v_lshlrev_b32 v32, 16, v112
    buffer_load_dwordx2 v[22:23], v9, s[12:15], s59 offen sc1
    v_and_b32 v33, 0xffff0000, v112
    buffer_load_dwordx4 a[8:11], v5, s[12:15], s58 offen offset:2048
    v_lshlrev_b32 v132, 16, v122
    buffer_load_dwordx4 a[12:15], v5, s[12:15], s58 offen offset:3072
    s_add_u32 s58, s58, 4096
    v_and_b32 v133, 0xffff0000, v122
    buffer_load_dwordx4 a[16:19], v5, s[12:15], s58 offen offset:0
    v_pk_add_f32 v[32:33], v[32:33], v[132:133]
    buffer_load_dwordx4 a[20:23], v5, s[12:15], s58 offen offset:1024
    v_lshlrev_b32 v34, 16, v113
    buffer_load_dwordx4 a[24:27], v5, s[12:15], s58 offen offset:2048
    v_and_b32 v35, 0xffff0000, v113
    buffer_load_dwordx4 a[28:31], v5, s[12:15], s58 offen offset:3072
    s_add_u32 s58, s58, 4096
    v_lshlrev_b32 v132, 16, v123
    buffer_load_dwordx4 a[32:35], v5, s[12:15], s58 offen offset:0
    v_and_b32 v133, 0xffff0000, v123
    buffer_load_dwordx4 a[36:39], v5, s[12:15], s58 offen offset:1024
    v_pk_add_f32 v[34:35], v[34:35], v[132:133]
    v_lshlrev_b32 v36, 16, v114
    v_and_b32 v37, 0xffff0000, v114
    v_lshlrev_b32 v132, 16, v124
    v_and_b32 v133, 0xffff0000, v124
    v_pk_add_f32 v[36:37], v[36:37], v[132:133]
    v_lshlrev_b32 v38, 16, v115
    v_and_b32 v39, 0xffff0000, v115
    v_lshlrev_b32 v132, 16, v125
    v_and_b32 v133, 0xffff0000, v125
    v_pk_add_f32 v[38:39], v[38:39], v[132:133]
    v_lshlrev_b32 v40, 16, v116
    v_and_b32 v41, 0xffff0000, v116
    v_lshlrev_b32 v132, 16, v126
    v_and_b32 v133, 0xffff0000, v126
    v_pk_add_f32 v[40:41], v[40:41], v[132:133]
    v_lshlrev_b32 v42, 16, v117
    v_and_b32 v43, 0xffff0000, v117
    v_lshlrev_b32 v132, 16, v127
    v_and_b32 v133, 0xffff0000, v127
    v_pk_add_f32 v[42:43], v[42:43], v[132:133]
    v_lshlrev_b32 v44, 16, v118
    v_and_b32 v45, 0xffff0000, v118
    v_lshlrev_b32 v132, 16, v128
    v_and_b32 v133, 0xffff0000, v128
    v_pk_add_f32 v[44:45], v[44:45], v[132:133]
    v_lshlrev_b32 v46, 16, v119
    v_and_b32 v47, 0xffff0000, v119
    v_lshlrev_b32 v132, 16, v129
    v_and_b32 v133, 0xffff0000, v129
    v_pk_add_f32 v[46:47], v[46:47], v[132:133]
    v_lshlrev_b32 v48, 16, v120
    v_and_b32 v49, 0xffff0000, v120
    v_lshlrev_b32 v132, 16, v130
    v_and_b32 v133, 0xffff0000, v130
    v_pk_add_f32 v[48:49], v[48:49], v[132:133]
    v_lshlrev_b32 v50, 16, v121
    v_and_b32 v51, 0xffff0000, v121
    v_lshlrev_b32 v132, 16, v131
    v_and_b32 v133, 0xffff0000, v131
    v_pk_add_f32 v[50:51], v[50:51], v[132:133]
    s_lshl_b32 s49, s26, 12
    v_mul_u32_u24 v18, 176, v3
    v_add_u32 v18, v18, v20
    v_add_u32 v18, s49, v18
    s_lshl_b32 s50, s26, 9
    s_add_u32 s50, s50, s24
    s_mul_i32 s50, s50, 1280
    s_add_u32 s50, s50, s45
    v_add_u32 v30, 0, v2
    v_mul_u32_u24 v31, 205, v30
    v_lshrrev_b32 v31, 11, v31
    v_mul_u32_u24 v19, 10, v31
    v_sub_u32 v30, v30, v19
    v_lshlrev_b32 v30, 4, v30
    v_mul_u32_u24 v24, 176, v31
    v_add_u32 v24, v24, v30
    v_add_u32 v24, s49, v24
    v_mul_u32_u24 v27, 0xa000, v31
    v_add_u32 v27, v27, v30
    v_add_u32 v30, 64, v2
    v_mul_u32_u24 v31, 205, v30
    v_lshrrev_b32 v31, 11, v31
    v_mul_u32_u24 v19, 10, v31
    v_sub_u32 v30, v30, v19
    v_lshlrev_b32 v30, 4, v30
    v_mul_u32_u24 v25, 176, v31
    v_add_u32 v25, v25, v30
    v_add_u32 v25, s49, v25
    v_mul_u32_u24 v28, 0xa000, v31
    v_add_u32 v28, v28, v30
    v_add_u32 v30, 128, v2
    v_mul_u32_u24 v31, 205, v30
    v_lshrrev_b32 v31, 11, v31
    v_mul_u32_u24 v19, 10, v31
    v_sub_u32 v30, v30, v19
    v_lshlrev_b32 v30, 4, v30
    v_mul_u32_u24 v26, 176, v31
    v_add_u32 v26, v26, v30
    v_add_u32 v26, s49, v26
    v_mul_u32_u24 v29, 0xa000, v31
    v_add_u32 v29, v29, v30
    v_cmp_gt_u32 vcc, 32, v2
    v_mov_b32 v30, 0x7ff00000
    s_nop 0
    v_cndmask_b32 v29, v30, v29, vcc
    buffer_load_dwordx4 a[40:43], v5, s[12:15], s58 offen offset:2048
    buffer_load_dwordx4 a[44:47], v5, s[12:15], s58 offen offset:3072
    s_add_u32 s58, s58, 4096
    s_waitcnt vmcnt(10)
    s_mov_b32 s44, 0
fnet_cd_kernel_chk:
    v_and_b32 v22, v22, v23
    s_nop 0
    v_readfirstlane_b32 s47, v22
    s_nop 0
    s_cmp_eq_u32 s47, 1
    s_cbranch_scc1 fnet_cd_kernel_go
    s_add_u32 s44, s44, 1
    s_cmp_gt_u32 s44, 0x100000
    s_cbranch_scc1 fnet_cd_kernel_go
    buffer_load_dwordx2 v[22:23], v9, s[12:15], s59 offen sc1
    s_waitcnt vmcnt(0)
    s_branch fnet_cd_kernel_chk
fnet_cd_kernel_go:
    buffer_load_dwordx4 v[136:139], v11, s[12:15], s48 offen sc1
    s_add_u32 s48, s48, 4096
    buffer_load_dwordx4 v[140:143], v11, s[12:15], s48 offen sc1
    s_add_u32 s48, s48, 4096
    buffer_load_dwordx4 v[144:147], v11, s[12:15], s48 offen sc1
    s_add_u32 s48, s48, 4096
    buffer_load_dwordx4 v[148:151], v11, s[12:15], s48 offen sc1
    s_add_u32 s48, s48, 4096
    buffer_load_dwordx4 v[152:155], v11, s[12:15], s48 offen sc1
    s_add_u32 s48, s48, 4096
    buffer_load_dwordx4 v[156:159], v11, s[12:15], s48 offen sc1
    s_add_u32 s48, s48, 4096
    buffer_load_dwordx4 v[160:163], v11, s[12:15], s48 offen sc1
    s_add_u32 s48, s48, 4096
    buffer_load_dwordx4 v[164:167], v11, s[12:15], s48 offen sc1
    s_add_u32 s48, s48, 4096
    s_waitcnt vmcnt(8)
    buffer_load_dwordx4 v[168:171], v11, s[12:15], s48 offen sc1
    s_add_u32 s48, s48, 4096
    s_waitcnt vmcnt(8)
    v_mfma_f32_16x16x32_bf16 v[52:55], a[64:67], v[136:139], 0
    buffer_load_dwordx4 v[172:175], v11, s[12:15], s48 offen sc1
    s_add_u32 s48, s48, 4096
    v_mfma_f32_16x16x32_bf16 v[56:59], a[68:71], v[136:139], 0
    v_mfma_f32_16x16x32_bf16 v[60:63], a[72:75], v[136:139], 0
    v_mfma_f32_16x16x32_bf16 v[64:67], a[76:79], v[136:139], 0
    v_mfma_f32_16x16x32_bf16 v[68:71], a[80:83], v[136:139], 0
    buffer_load_dwordx4 v[176:179], v11, s[12:15], s48 offen sc1
    s_add_u32 s48, s48, 4096
    s_waitcnt vmcnt(9)
    v_mfma_f32_16x16x32_bf16 v[52:55], a[84:87], v[140:143], v[52:55]
    v_mfma_f32_16x16x32_bf16 v[56:59], a[88:91], v[140:143], v[56:59]
    v_mfma_f32_16x16x32_bf16 v[60:63], a[92:95], v[140:143], v[60:63]
    v_mfma_f32_16x16x32_bf16 v[64:67], a[96:99], v[140:143], v[64:67]
    buffer_load_dwordx4 v[180:183], v11, s[12:15], s48 offen sc1
    s_sub_u32 s48, s48, 45056
    v_mfma_f32_16x16x32_bf16 v[68:71], a[100:103], v[140:143], v[68:71]
    s_waitcnt vmcnt(9)
    v_mfma_f32_16x16x32_bf16 v[52:55], a[104:107], v[144:147], v[52:55]
    v_mfma_f32_16x16x32_bf16 v[56:59], a[108:111], v[144:147], v[56:59]
    v_mfma_f32_16x16x32_bf16 v[60:63], a[112:115], v[144:147], v[60:63]
    buffer_load_dwordx4 v[184:187], v12, s[12:15], s48 offen sc1
    s_add_u32 s48, s48, 4096
    v_mfma_f32_16x16x32_bf16 v[64:67], a[116:119], v[144:147], v[64:67]
    v_mfma_f32_16x16x32_bf16 v[68:71], a[120:123], v[144:147], v[68:71]
    s_waitcnt vmcnt(9)
    v_mfma_f32_16x16x32_bf16 v[52:55], a[124:127], v[148:151], v[52:55]
    v_mfma_f32_16x16x32_bf16 v[56:59], a[128:131], v[148:151], v[56:59]
    v_mfma_f32_16x16x32_bf16 v[60:63], a[132:135], v[148:151], v[60:63]
    buffer_load_dwordx4 v[188:191], v12, s[12:15], s48 offen sc1
    s_add_u32 s48, s48, 4096
    v_mfma_f32_16x16x32_bf16 v[64:67], a[136:139], v[148:151], v[64:67]
    v_mfma_f32_16x16x32_bf16 v[68:71], a[140:143], v[148:151], v[68:71]
    s_waitcnt vmcnt(9)
    v_mfma_f32_16x16x32_bf16 v[52:55], a[144:147], v[152:155], v[52:55]
    v_mfma_f32_16x16x32_bf16 v[56:59], a[148:151], v[152:155], v[56:59]
    buffer_load_dwordx4 v[192:195], v12, s[12:15], s48 offen sc1
    s_add_u32 s48, s48, 4096
    v_mfma_f32_16x16x32_bf16 v[60:63], a[152:155], v[152:155], v[60:63]
    v_mfma_f32_16x16x32_bf16 v[64:67], a[156:159], v[152:155], v[64:67]
    v_mfma_f32_16x16x32_bf16 v[68:71], a[160:163], v[152:155], v[68:71]
    s_waitcnt vmcnt(9)
    v_mfma_f32_16x16x32_bf16 v[52:55], a[164:167], v[156:159], v[52:55]
    buffer_load_dwordx4 v[196:199], v12, s[12:15], s48 offen sc1
    s_add_u32 s48, s48, 4096
    v_mfma_f32_16x16x32_bf16 v[56:59], a[168:171], v[156:159], v[56:59]
    v_mfma_f32_16x16x32_bf16 v[60:63], a[172:175], v[156:159], v[60:63]
    v_mfma_f32_16x16x32_bf16 v[64:67], a[176:179], v[156:159], v[64:67]
    v_mfma_f32_16x16x32_bf16 v[68:71], a[180:183], v[156:159], v[68:71]
    buffer_load_dwordx4 v[200:203], v12, s[12:15], s48 offen sc1
    s_add_u32 s48, s48, 4096
    s_waitcnt vmcnt(10)
    v_mfma_f32_16x16x32_bf16 v[52:55], a[184:187], v[160:163], v[52:55]
    v_mfma_f32_16x16x32_bf16 v[56:59], a[188:191], v[160:163], v[56:59]
    v_mfma_f32_16x16x32_bf16 v[60:63], a[192:195], v[160:163], v[60:63]
    v_mfma_f32_16x16x32_bf16 v[64:67], a[196:199], v[160:163], v[64:67]
    buffer_load_dwordx4 v[204:207], v12, s[12:15], s48 offen sc1
    s_add_u32 s48, s48, 4096
    v_mfma_f32_16x16x32_bf16 v[68:71], a[200:203], v[160:163], v[68:71]
    s_waitcnt vmcnt(10)
    v_mfma_f32_16x16x32_bf16 v[52:55], a[204:207], v[164:167], v[52:55]
    v_mfma_f32_16x16x32_bf16 v[56:59], a[208:211], v[164:167], v[56:59]
    v_mfma_f32_16x16x32_bf16 v[60:63], a[212:215], v[164:167], v[60:63]
    v_mfma_f32_16x16x32_bf16 v[64:67], a[216:219], v[164:167], v[64:67]
    buffer_load_dwordx4 v[208:211], v12, s[12:15], s48 offen sc1
    s_add_u32 s48, s48, 4096
    v_mfma_f32_16x16x32_bf16 v[68:71], a[220:223], v[164:167], v[68:71]
    s_waitcnt vmcnt(10)
    v_mfma_f32_16x16x32_bf16 v[52:55], a[224:227], v[168:171], v[52:55]
    v_mfma_f32_16x16x32_bf16 v[56:59], a[228:231], v[168:171], v[56:59]
    v_mfma_f32_16x16x32_bf16 v[60:63], a[232:235], v[168:171], v[60:63]
    buffer_load_dwordx4 v[212:215], v12, s[12:15], s48 offen sc1
    s_add_u32 s48, s48, 4096
    v_mfma_f32_16x16x32_bf16 v[64:67], a[236:239], v[168:171], v[64:67]
    v_mfma_f32_16x16x32_bf16 v[68:71], a[240:243], v[168:171], v[68:71]
    s_waitcnt vmcnt(10)
    v_mfma_f32_16x16x32_bf16 v[52:55], a[244:247], v[172:175], v[52:55]
    v_mfma_f32_16x16x32_bf16 v[56:59], a[248:251], v[172:175], v[56:59]
    buffer_load_dwordx4 v[216:219], v12, s[12:15], s48 offen sc1
    s_add_u32 s48, s48, 4096
    v_mfma_f32_16x16x32_bf16 v[60:63], a[252:255], v[172:175], v[60:63]
    v_mfma_f32_16x16x32_bf16 v[64:67], a[0:3], v[172:175], v[64:67]
    v_mfma_f32_16x16x32_bf16 v[68:71], a[4:7], v[172:175], v[68:71]
    s_waitcnt vmcnt(10)
    v_mfma_f32_16x16x32_bf16 v[52:55], a[8:11], v[176:179], v[52:55]
    buffer_load_dwordx4 v[220:223], v12, s[12:15], s48 offen sc1
    s_add_u32 s48, s48, 4096
    v_mfma_f32_16x16x32_bf16 v[56:59], a[12:15], v[176:179], v[56:59]
    v_mfma_f32_16x16x32_bf16 v[60:63], a[16:19], v[176:179], v[60:63]
    v_mfma_f32_16x16x32_bf16 v[64:67], a[20:23], v[176:179], v[64:67]
    v_mfma_f32_16x16x32_bf16 v[68:71], a[24:27], v[176:179], v[68:71]
    s_waitcnt vmcnt(10)
    v_mfma_f32_16x16x32_bf16 v[52:55], a[28:31], v[180:183], v[52:55]
    buffer_load_dwordx4 v[224:227], v12, s[12:15], s48 offen sc1
    s_add_u32 s48, s48, 4096
    v_mfma_f32_16x16x32_bf16 v[56:59], a[32:35], v[180:183], v[56:59]
    v_mfma_f32_16x16x32_bf16 v[60:63], a[36:39], v[180:183], v[60:63]
    v_mfma_f32_16x16x32_bf16 v[64:67], a[40:43], v[180:183], v[64:67]
    v_mfma_f32_16x16x32_bf16 v[68:71], a[44:47], v[180:183], v[68:71]
    buffer_load_dwordx4 v[228:231], v12, s[12:15], s48 offen sc1
    s_sub_u32 s48, s48, 45056
    s_waitcnt vmcnt(11)
    v_mfma_f32_16x16x32_bf16 v[72:75], a[64:67], v[184:187], 0
    v_mfma_f32_16x16x32_bf16 v[76:79], a[68:71], v[184:187], 0
    v_mfma_f32_16x16x32_bf16 v[80:83], a[72:75], v[184:187], 0
    v_mfma_f32_16x16x32_bf16 v[84:87], a[76:79], v[184:187], 0
    buffer_load_dwordx4 v[232:235], v13, s[12:15], s48 offen sc1
    s_add_u32 s48, s48, 4096
    v_mfma_f32_16x16x32_bf16 v[88:91], a[80:83], v[184:187], 0
    s_waitcnt vmcnt(11)
    v_mfma_f32_16x16x32_bf16 v[72:75], a[84:87], v[188:191], v[72:75]
    v_mfma_f32_16x16x32_bf16 v[76:79], a[88:91], v[188:191], v[76:79]
    v_mfma_f32_16x16x32_bf16 v[80:83], a[92:95], v[188:191], v[80:83]
    buffer_load_dwordx4 v[236:239], v13, s[12:15], s48 offen sc1
    s_add_u32 s48, s48, 4096
    v_mfma_f32_16x16x32_bf16 v[84:87], a[96:99], v[188:191], v[84:87]
    v_mfma_f32_16x16x32_bf16 v[88:91], a[100:103], v[188:191], v[88:91]
    s_waitcnt vmcnt(11)
    v_mfma_f32_16x16x32_bf16 v[72:75], a[104:107], v[192:195], v[72:75]
    ds_write_b128 v15, v[52:55] offset:0
    buffer_load_dwordx4 v[240:243], v13, s[12:15], s48 offen sc1
    s_add_u32 s48, s48, 4096
    v_mfma_f32_16x16x32_bf16 v[76:79], a[108:111], v[192:195], v[76:79]
    ds_write_b128 v15, v[56:59] offset:1024
    v_mfma_f32_16x16x32_bf16 v[80:83], a[112:115], v[192:195], v[80:83]
    ds_write_b128 v15, v[60:63] offset:2048
    buffer_load_dwordx4 v[244:247], v13, s[12:15], s48 offen sc1
    s_add_u32 s48, s48, 4096
    v_mfma_f32_16x16x32_bf16 v[84:87], a[116:119], v[192:195], v[84:87]
    ds_write_b128 v15, v[64:67] offset:3072
    v_mfma_f32_16x16x32_bf16 v[88:91], a[120:123], v[192:195], v[88:91]
    ds_write_b128 v15, v[68:71] offset:4096
    buffer_load_dwordx4 v[248:251], v13, s[12:15], s48 offen sc1
    s_add_u32 s48, s48, 4096
    s_waitcnt vmcnt(13)
    v_mfma_f32_16x16x32_bf16 v[72:75], a[124:127], v[196:199], v[72:75]
    v_mfma_f32_16x16x32_bf16 v[76:79], a[128:131], v[196:199], v[76:79]
    v_mfma_f32_16x16x32_bf16 v[80:83], a[132:135], v[196:199], v[80:83]
    buffer_load_dwordx4 v[252:255], v13, s[12:15], s48 offen sc1
    s_add_u32 s48, s48, 4096
    v_mfma_f32_16x16x32_bf16 v[84:87], a[136:139], v[196:199], v[84:87]
    v_mfma_f32_16x16x32_bf16 v[88:91], a[140:143], v[196:199], v[88:91]
    s_waitcnt vmcnt(13)
    v_mfma_f32_16x16x32_bf16 v[72:75], a[144:147], v[200:203], v[72:75]
    v_mfma_f32_16x16x32_bf16 v[76:79], a[148:151], v[200:203], v[76:79]
    v_mfma_f32_16x16x32_bf16 v[80:83], a[152:155], v[200:203], v[80:83]
    buffer_load_dwordx4 v[136:139], v13, s[12:15], s48 offen sc1
    s_add_u32 s48, s48, 4096
    v_mfma_f32_16x16x32_bf16 v[84:87], a[156:159], v[200:203], v[84:87]
    v_mfma_f32_16x16x32_bf16 v[88:91], a[160:163], v[200:203], v[88:91]
    s_waitcnt vmcnt(13)
    v_mfma_f32_16x16x32_bf16 v[72:75], a[164:167], v[204:207], v[72:75]
    v_mfma_f32_16x16x32_bf16 v[76:79], a[168:171], v[204:207], v[76:79]
    buffer_load_dwordx4 v[140:143], v13, s[12:15], s48 offen sc1
    s_add_u32 s48, s48, 4096
    v_mfma_f32_16x16x32_bf16 v[80:83], a[172:175], v[204:207], v[80:83]
    v_mfma_f32_16x16x32_bf16 v[84:87], a[176:179], v[204:207], v[84:87]
    v_mfma_f32_16x16x32_bf16 v[88:91], a[180:183], v[204:207], v[88:91]
    s_waitcnt vmcnt(13)
    v_mfma_f32_16x16x32_bf16 v[72:75], a[184:187], v[208:211], v[72:75]
    buffer_load_dwordx4 v[144:147], v13, s[12:15], s48 offen sc1
    s_add_u32 s48, s48, 4096
    v_mfma_f32_16x16x32_bf16 v[76:79], a[188:191], v[208:211], v[76:79]
    v_mfma_f32_16x16x32_bf16 v[80:83], a[192:195], v[208:211], v[80:83]
    v_mfma_f32_16x16x32_bf16 v[84:87], a[196:199], v[208:211], v[84:87]
    v_mfma_f32_16x16x32_bf16 v[88:91], a[200:203], v[208:211], v[88:91]
    buffer_load_dwordx4 v[148:151], v13, s[12:15], s48 offen sc1
    s_add_u32 s48, s48, 4096
    s_waitcnt vmcnt(14)
    v_mfma_f32_16x16x32_bf16 v[72:75], a[204:207], v[212:215], v[72:75]
    v_mfma_f32_16x16x32_bf16 v[76:79], a[208:211], v[212:215], v[76:79]
    v_mfma_f32_16x16x32_bf16 v[80:83], a[212:215], v[212:215], v[80:83]
    v_mfma_f32_16x16x32_bf16 v[84:87], a[216:219], v[212:215], v[84:87]
    buffer_load_dwordx4 v[152:155], v13, s[12:15], s48 offen sc1
    s_add_u32 s48, s48, 4096
    v_mfma_f32_16x16x32_bf16 v[88:91], a[220:223], v[212:215], v[88:91]
    s_waitcnt vmcnt(14)
    v_mfma_f32_16x16x32_bf16 v[72:75], a[224:227], v[216:219], v[72:75]
    v_mfma_f32_16x16x32_bf16 v[76:79], a[228:231], v[216:219], v[76:79]
    v_mfma_f32_16x16x32_bf16 v[80:83], a[232:235], v[216:219], v[80:83]
    v_mfma_f32_16x16x32_bf16 v[84:87], a[236:239], v[216:219], v[84:87]
    buffer_load_dwordx4 v[156:159], v13, s[12:15], s48 offen sc1
    s_sub_u32 s48, s48, 45056
    v_mfma_f32_16x16x32_bf16 v[88:91], a[240:243], v[216:219], v[88:91]
    s_waitcnt vmcnt(14)
    v_mfma_f32_16x16x32_bf16 v[72:75], a[244:247], v[220:223], v[72:75]
    v_mfma_f32_16x16x32_bf16 v[76:79], a[248:251], v[220:223], v[76:79]
    v_mfma_f32_16x16x32_bf16 v[80:83], a[252:255], v[220:223], v[80:83]
    buffer_load_dwordx4 v[160:163], v10, s[12:15], s48 offen sc1
    s_add_u32 s48, s48, 4096
    v_mfma_f32_16x16x32_bf16 v[84:87], a[0:3], v[220:223], v[84:87]
    v_mfma_f32_16x16x32_bf16 v[88:91], a[4:7], v[220:223], v[88:91]
    s_waitcnt vmcnt(14)
    v_mfma_f32_16x16x32_bf16 v[72:75], a[8:11], v[224:227], v[72:75]
    v_mfma_f32_16x16x32_bf16 v[76:79], a[12:15], v[224:227], v[76:79]
    buffer_load_dwordx4 v[164:167], v10, s[12:15], s48 offen sc1
    s_add_u32 s48, s48, 4096
    v_mfma_f32_16x16x32_bf16 v[80:83], a[16:19], v[224:227], v[80:83]
    v_mfma_f32_16x16x32_bf16 v[84:87], a[20:23], v[224:227], v[84:87]
    v_mfma_f32_16x16x32_bf16 v[88:91], a[24:27], v[224:227], v[88:91]
    s_waitcnt vmcnt(14)
    v_mfma_f32_16x16x32_bf16 v[72:75], a[28:31], v[228:231], v[72:75]
    buffer_load_dwordx4 v[168:171], v10, s[12:15], s48 offen sc1
    s_add_u32 s48, s48, 4096
    v_mfma_f32_16x16x32_bf16 v[76:79], a[32:35], v[228:231], v[76:79]
    v_mfma_f32_16x16x32_bf16 v[80:83], a[36:39], v[228:231], v[80:83]
    v_mfma_f32_16x16x32_bf16 v[84:87], a[40:43], v[228:231], v[84:87]
    v_mfma_f32_16x16x32_bf16 v[88:91], a[44:47], v[228:231], v[88:91]
    s_waitcnt vmcnt(14)
    v_mfma_f32_16x16x32_bf16 v[92:95], a[64:67], v[232:235], 0
    buffer_load_dwordx4 v[172:175], v10, s[12:15], s48 offen sc1
    s_add_u32 s48, s48, 4096
    v_mfma_f32_16x16x32_bf16 v[96:99], a[68:71], v[232:235], 0
    v_mfma_f32_16x16x32_bf16 v[100:103], a[72:75], v[232:235], 0
    v_mfma_f32_16x16x32_bf16 v[104:107], a[76:79], v[232:235], 0
    v_mfma_f32_16x16x32_bf16 v[108:111], a[80:83], v[232:235], 0
    buffer_load_dwordx4 v[176:179], v10, s[12:15], s48 offen sc1
    s_add_u32 s48, s48, 4096
    s_waitcnt vmcnt(15)
    v_mfma_f32_16x16x32_bf16 v[92:95], a[84:87], v[236:239], v[92:95]
    v_mfma_f32_16x16x32_bf16 v[96:99], a[88:91], v[236:239], v[96:99]
    v_mfma_f32_16x16x32_bf16 v[100:103], a[92:95], v[236:239], v[100:103]
    v_mfma_f32_16x16x32_bf16 v[104:107], a[96:99], v[236:239], v[104:107]
    buffer_load_dwordx4 v[180:183], v10, s[12:15], s48 offen sc1
    s_add_u32 s48, s48, 4096
    v_mfma_f32_16x16x32_bf16 v[108:111], a[100:103], v[236:239], v[108:111]
    s_waitcnt vmcnt(15)
    v_mfma_f32_16x16x32_bf16 v[92:95], a[104:107], v[240:243], v[92:95]
    ds_write_b128 v16, v[72:75] offset:5120
    v_mfma_f32_16x16x32_bf16 v[96:99], a[108:111], v[240:243], v[96:99]
    buffer_load_dwordx4 v[184:187], v10, s[12:15], s48 offen sc1
    s_add_u32 s48, s48, 4096
    ds_write_b128 v16, v[76:79] offset:6144
    v_mfma_f32_16x16x32_bf16 v[100:103], a[112:115], v[240:243], v[100:103]
    ds_write_b128 v16, v[80:83] offset:7168
    buffer_load_dwordx4 v[188:191], v10, s[12:15], s48 offen sc1
    s_add_u32 s48, s48, 4096
    v_mfma_f32_16x16x32_bf16 v[104:107], a[116:119], v[240:243], v[104:107]
    ds_write_b128 v16, v[84:87] offset:8192
    v_mfma_f32_16x16x32_bf16 v[108:111], a[120:123], v[240:243], v[108:111]
    ds_write_b128 v16, v[88:91] offset:9216
    buffer_load_dwordx4 v[192:195], v10, s[12:15], s48 offen sc1
    s_add_u32 s48, s48, 4096
    s_waitcnt vmcnt(17)
    v_mfma_f32_16x16x32_bf16 v[92:95], a[124:127], v[244:247], v[92:95]
    v_mfma_f32_16x16x32_bf16 v[96:99], a[128:131], v[244:247], v[96:99]
    v_mfma_f32_16x16x32_bf16 v[100:103], a[132:135], v[244:247], v[100:103]
    v_mfma_f32_16x16x32_bf16 v[104:107], a[136:139], v[244:247], v[104:107]
    buffer_load_dwordx4 v[196:199], v10, s[12:15], s48 offen sc1
    s_add_u32 s48, s48, 4096
    v_mfma_f32_16x16x32_bf16 v[108:111], a[140:143], v[244:247], v[108:111]
    s_waitcnt vmcnt(17)
    v_mfma_f32_16x16x32_bf16 v[92:95], a[144:147], v[248:251], v[92:95]
    v_mfma_f32_16x16x32_bf16 v[96:99], a[148:151], v[248:251], v[96:99]
    v_mfma_f32_16x16x32_bf16 v[100:103], a[152:155], v[248:251], v[100:103]
    buffer_load_dwordx4 v[200:203], v10, s[12:15], s48 offen sc1
    s_add_u32 s48, s48, 4096
    v_mfma_f32_16x16x32_bf16 v[104:107], a[156:159], v[248:251], v[104:107]
    v_mfma_f32_16x16x32_bf16 v[108:111], a[160:163], v[248:251], v[108:111]
    s_waitcnt vmcnt(17)
    v_mfma_f32_16x16x32_bf16 v[92:95], a[164:167], v[252:255], v[92:95]
    v_mfma_f32_16x16x32_bf16 v[96:99], a[168:171], v[252:255], v[96:99]
    v_mfma_f32_16x16x32_bf16 v[100:103], a[172:175], v[252:255], v[100:103]
    buffer_load_dwordx4 v[204:207], v10, s[12:15], s48 offen sc1
    s_sub_u32 s48, s48, 45056
    v_mfma_f32_16x16x32_bf16 v[104:107], a[176:179], v[252:255], v[104:107]
    v_mfma_f32_16x16x32_bf16 v[108:111], a[180:183], v[252:255], v[108:111]
    s_waitcnt vmcnt(17)
    v_mfma_f32_16x16x32_bf16 v[92:95], a[184:187], v[136:139], v[92:95]
    v_mfma_f32_16x16x32_bf16 v[96:99], a[188:191], v[136:139], v[96:99]
    v_mfma_f32_16x16x32_bf16 v[100:103], a[192:195], v[136:139], v[100:103]
    v_mfma_f32_16x16x32_bf16 v[104:107], a[196:199], v[136:139], v[104:107]
    v_mfma_f32_16x16x32_bf16 v[108:111], a[200:203], v[136:139], v[108:111]
    s_waitcnt vmcnt(16)
    v_mfma_f32_16x16x32_bf16 v[92:95], a[204:207], v[140:143], v[92:95]
    v_mfma_f32_16x16x32_bf16 v[96:99], a[208:211], v[140:143], v[96:99]
    v_mfma_f32_16x16x32_bf16 v[100:103], a[212:215], v[140:143], v[100:103]
    v_mfma_f32_16x16x32_bf16 v[104:107], a[216:219], v[140:143], v[104:107]
    v_mfma_f32_16x16x32_bf16 v[108:111], a[220:223], v[140:143], v[108:111]
    s_waitcnt vmcnt(15)
    v_mfma_f32_16x16x32_bf16 v[92:95], a[224:227], v[144:147], v[92:95]
    v_mfma_f32_16x16x32_bf16 v[96:99], a[228:231], v[144:147], v[96:99]
    v_mfma_f32_16x16x32_bf16 v[100:103], a[232:235], v[144:147], v[100:103]
    v_mfma_f32_16x16x32_bf16 v[104:107], a[236:239], v[144:147], v[104:107]
    v_mfma_f32_16x16x32_bf16 v[108:111], a[240:243], v[144:147], v[108:111]
    s_waitcnt vmcnt(14)
    v_mfma_f32_16x16x32_bf16 v[92:95], a[244:247], v[148:151], v[92:95]
    v_mfma_f32_16x16x32_bf16 v[96:99], a[248:251], v[148:151], v[96:99]
    v_mfma_f32_16x16x32_bf16 v[100:103], a[252:255], v[148:151], v[100:103]
    v_mfma_f32_16x16x32_bf16 v[104:107], a[0:3], v[148:151], v[104:107]
    v_mfma_f32_16x16x32_bf16 v[108:111], a[4:7], v[148:151], v[108:111]
    s_waitcnt vmcnt(13)
    v_mfma_f32_16x16x32_bf16 v[92:95], a[8:11], v[152:155], v[92:95]
    v_mfma_f32_16x16x32_bf16 v[96:99], a[12:15], v[152:155], v[96:99]
    v_mfma_f32_16x16x32_bf16 v[100:103], a[16:19], v[152:155], v[100:103]
    v_mfma_f32_16x16x32_bf16 v[104:107], a[20:23], v[152:155], v[104:107]
    v_mfma_f32_16x16x32_bf16 v[108:111], a[24:27], v[152:155], v[108:111]
    s_waitcnt vmcnt(12)
    v_mfma_f32_16x16x32_bf16 v[92:95], a[28:31], v[156:159], v[92:95]
    v_mfma_f32_16x16x32_bf16 v[96:99], a[32:35], v[156:159], v[96:99]
    v_mfma_f32_16x16x32_bf16 v[100:103], a[36:39], v[156:159], v[100:103]
    v_mfma_f32_16x16x32_bf16 v[104:107], a[40:43], v[156:159], v[104:107]
    v_mfma_f32_16x16x32_bf16 v[108:111], a[44:47], v[156:159], v[108:111]
    s_waitcnt vmcnt(11)
    v_mfma_f32_16x16x32_bf16 v[32:35], a[64:67], v[160:163], v[32:35]
    v_mfma_f32_16x16x32_bf16 v[36:39], a[68:71], v[160:163], v[36:39]
    v_mfma_f32_16x16x32_bf16 v[40:43], a[72:75], v[160:163], v[40:43]
    v_mfma_f32_16x16x32_bf16 v[44:47], a[76:79], v[160:163], v[44:47]
    v_mfma_f32_16x16x32_bf16 v[48:51], a[80:83], v[160:163], v[48:51]
    s_waitcnt vmcnt(10)
    v_mfma_f32_16x16x32_bf16 v[32:35], a[84:87], v[164:167], v[32:35]
    v_mfma_f32_16x16x32_bf16 v[36:39], a[88:91], v[164:167], v[36:39]
    v_mfma_f32_16x16x32_bf16 v[40:43], a[92:95], v[164:167], v[40:43]
    v_mfma_f32_16x16x32_bf16 v[44:47], a[96:99], v[164:167], v[44:47]
    v_mfma_f32_16x16x32_bf16 v[48:51], a[100:103], v[164:167], v[48:51]
    s_waitcnt vmcnt(9)
    v_mfma_f32_16x16x32_bf16 v[32:35], a[104:107], v[168:171], v[32:35]
    ds_write_b128 v17, v[92:95] offset:10240
    v_mfma_f32_16x16x32_bf16 v[36:39], a[108:111], v[168:171], v[36:39]
    ds_write_b128 v17, v[96:99] offset:11264
    v_mfma_f32_16x16x32_bf16 v[40:43], a[112:115], v[168:171], v[40:43]
    ds_write_b128 v17, v[100:103] offset:12288
    v_mfma_f32_16x16x32_bf16 v[44:47], a[116:119], v[168:171], v[44:47]
    ds_write_b128 v17, v[104:107] offset:13312
    v_mfma_f32_16x16x32_bf16 v[48:51], a[120:123], v[168:171], v[48:51]
    ds_write_b128 v17, v[108:111] offset:14336
    s_waitcnt vmcnt(8)
    v_mfma_f32_16x16x32_bf16 v[32:35], a[124:127], v[172:175], v[32:35]
    v_mfma_f32_16x16x32_bf16 v[36:39], a[128:131], v[172:175], v[36:39]
    v_mfma_f32_16x16x32_bf16 v[40:43], a[132:135], v[172:175], v[40:43]
    v_mfma_f32_16x16x32_bf16 v[44:47], a[136:139], v[172:175], v[44:47]
    v_mfma_f32_16x16x32_bf16 v[48:51], a[140:143], v[172:175], v[48:51]
    s_waitcnt vmcnt(7)
    v_mfma_f32_16x16x32_bf16 v[32:35], a[144:147], v[176:179], v[32:35]
    v_mfma_f32_16x16x32_bf16 v[36:39], a[148:151], v[176:179], v[36:39]
    v_mfma_f32_16x16x32_bf16 v[40:43], a[152:155], v[176:179], v[40:43]
    v_mfma_f32_16x16x32_bf16 v[44:47], a[156:159], v[176:179], v[44:47]
    v_mfma_f32_16x16x32_bf16 v[48:51], a[160:163], v[176:179], v[48:51]
    s_waitcnt lgkmcnt(0)
    s_barrier
    s_waitcnt vmcnt(6)
    v_mfma_f32_16x16x32_bf16 v[32:35], a[164:167], v[180:183], v[32:35]
    ds_read_b128 v[52:55], v14 offset:0
    v_mfma_f32_16x16x32_bf16 v[36:39], a[168:171], v[180:183], v[36:39]
    ds_read_b128 v[56:59], v14 offset:1024
    v_mfma_f32_16x16x32_bf16 v[40:43], a[172:175], v[180:183], v[40:43]
    ds_read_b128 v[60:63], v14 offset:2048
    v_mfma_f32_16x16x32_bf16 v[44:47], a[176:179], v[180:183], v[44:47]
    ds_read_b128 v[64:67], v14 offset:3072
    v_mfma_f32_16x16x32_bf16 v[48:51], a[180:183], v[180:183], v[48:51]
    ds_read_b128 v[68:71], v14 offset:4096
    s_waitcnt vmcnt(5)
    v_mfma_f32_16x16x32_bf16 v[32:35], a[184:187], v[184:187], v[32:35]
    ds_read_b128 v[72:75], v14 offset:5120
    v_mfma_f32_16x16x32_bf16 v[36:39], a[188:191], v[184:187], v[36:39]
    ds_read_b128 v[76:79], v14 offset:6144
    v_mfma_f32_16x16x32_bf16 v[40:43], a[192:195], v[184:187], v[40:43]
    ds_read_b128 v[80:83], v14 offset:7168
    v_mfma_f32_16x16x32_bf16 v[44:47], a[196:199], v[184:187], v[44:47]
    ds_read_b128 v[84:87], v14 offset:8192
    v_mfma_f32_16x16x32_bf16 v[48:51], a[200:203], v[184:187], v[48:51]
    ds_read_b128 v[88:91], v14 offset:9216
    s_waitcnt vmcnt(4)
    v_mfma_f32_16x16x32_bf16 v[32:35], a[204:207], v[188:191], v[32:35]
    ds_read_b128 v[92:95], v14 offset:10240
    v_mfma_f32_16x16x32_bf16 v[36:39], a[208:211], v[188:191], v[36:39]
    ds_read_b128 v[96:99], v14 offset:11264
    v_mfma_f32_16x16x32_bf16 v[40:43], a[212:215], v[188:191], v[40:43]
    ds_read_b128 v[100:103], v14 offset:12288
    v_mfma_f32_16x16x32_bf16 v[44:47], a[216:219], v[188:191], v[44:47]
    ds_read_b128 v[104:107], v14 offset:13312
    v_mfma_f32_16x16x32_bf16 v[48:51], a[220:223], v[188:191], v[48:51]
    ds_read_b128 v[108:111], v14 offset:14336
    s_waitcnt vmcnt(3)
    v_mfma_f32_16x16x32_bf16 v[32:35], a[224:227], v[192:195], v[32:35]
    v_mfma_f32_16x16x32_bf16 v[36:39], a[228:231], v[192:195], v[36:39]
    v_mfma_f32_16x16x32_bf16 v[40:43], a[232:235], v[192:195], v[40:43]
    v_mfma_f32_16x16x32_bf16 v[44:47], a[236:239], v[192:195], v[44:47]
    v_mfma_f32_16x16x32_bf16 v[48:51], a[240:243], v[192:195], v[48:51]
    s_waitcnt lgkmcnt(0)
    s_waitcnt vmcnt(2)
    v_mfma_f32_16x16x32_bf16 v[32:35], a[244:247], v[196:199], v[32:35]
    v_add_f32 v52, v52, v72
    v_add_f32 v53, v53, v73
    v_mfma_f32_16x16x32_bf16 v[36:39], a[248:251], v[196:199], v[36:39]
    v_add_f32 v54, v54, v74
    v_add_f32 v55, v55, v75
    v_mfma_f32_16x16x32_bf16 v[40:43], a[252:255], v[196:199], v[40:43]
    v_add_f32 v56, v56, v76
    v_add_f32 v57, v57, v77
    v_mfma_f32_16x16x32_bf16 v[44:47], a[0:3], v[196:199], v[44:47]
    v_add_f32 v58, v58, v78
    v_add_f32 v59, v59, v79
    v_mfma_f32_16x16x32_bf16 v[48:51], a[4:7], v[196:199], v[48:51]
    v_add_f32 v60, v60, v80
    v_add_f32 v61, v61, v81
    s_waitcnt vmcnt(1)
    v_mfma_f32_16x16x32_bf16 v[32:35], a[8:11], v[200:203], v[32:35]
    v_add_f32 v62, v62, v82
    v_add_f32 v63, v63, v83
    v_mfma_f32_16x16x32_bf16 v[36:39], a[12:15], v[200:203], v[36:39]
    v_add_f32 v64, v64, v84
    v_add_f32 v65, v65, v85
    v_mfma_f32_16x16x32_bf16 v[40:43], a[16:19], v[200:203], v[40:43]
    v_add_f32 v66, v66, v86
    v_add_f32 v67, v67, v87
    v_mfma_f32_16x16x32_bf16 v[44:47], a[20:23], v[200:203], v[44:47]
    v_add_f32 v68, v68, v88
    v_add_f32 v69, v69, v89
    v_mfma_f32_16x16x32_bf16 v[48:51], a[24:27], v[200:203], v[48:51]
    v_add_f32 v70, v70, v90
    v_add_f32 v71, v71, v91
    s_waitcnt vmcnt(0)
    v_mfma_f32_16x16x32_bf16 v[32:35], a[28:31], v[204:207], v[32:35]
    v_add_f32 v52, v52, v92
    v_add_f32 v53, v53, v93
    v_mfma_f32_16x16x32_bf16 v[36:39], a[32:35], v[204:207], v[36:39]
    v_add_f32 v54, v54, v94
    v_add_f32 v55, v55, v95
    v_mfma_f32_16x16x32_bf16 v[40:43], a[36:39], v[204:207], v[40:43]
    v_add_f32 v56, v56, v96
    v_add_f32 v57, v57, v97
    v_mfma_f32_16x16x32_bf16 v[44:47], a[40:43], v[204:207], v[44:47]
    v_add_f32 v58, v58, v98
    v_add_f32 v59, v59, v99
    v_mfma_f32_16x16x32_bf16 v[48:51], a[44:47], v[204:207], v[48:51]
    v_add_f32 v60, v60, v100
    v_add_f32 v61, v61, v101
    v_add_f32 v62, v62, v102
    v_add_f32 v63, v63, v103
    v_add_f32 v64, v64, v104
    v_add_f32 v65, v65, v105
    v_add_f32 v66, v66, v106
    v_add_f32 v67, v67, v107
    v_add_f32 v68, v68, v108
    v_add_f32 v69, v69, v109
    v_add_f32 v70, v70, v110
    v_add_f32 v71, v71, v111
    v_pk_add_f32 v[32:33], v[32:33], v[52:53]
    v_pk_add_f32 v[34:35], v[34:35], v[54:55]
    v_cvt_pk_bf16_f32 v112, v32, v33
    v_cvt_pk_bf16_f32 v113, v34, v35
    ds_write_b64 v18, v[112:113] offset:0
    v_pk_add_f32 v[36:37], v[36:37], v[56:57]
    v_pk_add_f32 v[38:39], v[38:39], v[58:59]
    v_cvt_pk_bf16_f32 v114, v36, v37
    v_cvt_pk_bf16_f32 v115, v38, v39
    ds_write_b64 v18, v[114:115] offset:32
    v_pk_add_f32 v[40:41], v[40:41], v[60:61]
    v_pk_add_f32 v[42:43], v[42:43], v[62:63]
    v_cvt_pk_bf16_f32 v116, v40, v41
    v_cvt_pk_bf16_f32 v117, v42, v43
    ds_write_b64 v18, v[116:117] offset:64
    v_pk_add_f32 v[44:45], v[44:45], v[64:65]
    v_pk_add_f32 v[46:47], v[46:47], v[66:67]
    v_cvt_pk_bf16_f32 v118, v44, v45
    v_cvt_pk_bf16_f32 v119, v46, v47
    ds_write_b64 v18, v[118:119] offset:96
    v_pk_add_f32 v[48:49], v[48:49], v[68:69]
    v_pk_add_f32 v[50:51], v[50:51], v[70:71]
    v_cvt_pk_bf16_f32 v120, v48, v49
    v_cvt_pk_bf16_f32 v121, v50, v51
    ds_write_b64 v18, v[120:121] offset:128
    ds_read_b128 v[136:139], v24
    ds_read_b128 v[140:143], v25
    ds_read_b128 v[144:147], v26
    s_waitcnt lgkmcnt(2)
    buffer_store_dwordx4 v[136:139], v27, s[84:87], s50 offen
    s_waitcnt lgkmcnt(1)
    buffer_store_dwordx4 v[140:143], v28, s[84:87], s50 offen
    s_waitcnt lgkmcnt(0)
    buffer_store_dwordx4 v[144:147], v29, s[84:87], s50 offen
fnet_cd_kernel_end:
    s_endpgm
.section .rodata,"a"
.p2align 6
.amdhsa_kernel fnet_a_kernel
  .amdhsa_next_free_vgpr 120
  .amdhsa_next_free_sgpr 80
  .amdhsa_accum_offset 120
  .amdhsa_group_segment_fixed_size 0
  .amdhsa_kernarg_size 104
  .amdhsa_user_sgpr_count 2
  .amdhsa_user_sgpr_kernarg_segment_ptr 1
  .amdhsa_system_sgpr_workgroup_id_x 1
.end_amdhsa_kernel

.p2align 6
.amdhsa_kernel fnet_cd_kernel
  .amdhsa_next_free_vgpr 512
  .amdhsa_next_free_sgpr 96
  .amdhsa_accum_offset 256
  .amdhsa_group_segment_fixed_size 0
  .amdhsa_kernarg_size 104
  .amdhsa_user_sgpr_count 2
  .amdhsa_user_sgpr_kernarg_segment_ptr 1
  .amdhsa_system_sgpr_workgroup_id_x 1
.end_amdhsa_kernel
```
